```python
import torch

def _softmax(x, axis=-1):
    return torch.softmax(x, dim=axis)
def _gelu(x):
    return torch.nn.functional.gelu(x, approximate="tanh")
def _silu(x):
    return torch.nn.functional.silu(x)
def _sigmoid(x):
    return torch.sigmoid(x)
def _layernorm(x, axis=-1, eps=1e-5):
    m = x.mean(dim=axis, keepdim=True)
    v = x.var(dim=axis, keepdim=True, unbiased=False)
    return (x - m) / torch.sqrt(v + eps)
def _scatter_add(tgt, idx, src, axis=0):
    return tgt.clone().index_add_(axis, idx, src)
def _segment_sum(src, seg, n):
    out = torch.zeros((n,) + src.shape[1:], dtype=src.dtype)
    return out.index_add_(0, seg, src)
def _pad(x, pw):
    flat = tuple(v for pair in reversed(pw) for v in pair)
    return torch.nn.functional.pad(x, flat)

kernel_name = 'standalone__self_sup_conv_stem_wavlm__speech'

def setup_inputs():

    _w = (lambda a: (lambda t: t.to(torch.bfloat16) if t.is_floating_point() else t)(torch.as_tensor(a)))
    B, T, D, K = 2, 16000, 256, 3
    scale = (K * D) ** -0.5
    return {
        "x": _w((lambda *s: torch.randn(*s, dtype=torch.bfloat16) * 0.05)(B, T, D)),
        "w": _w((lambda *s: torch.randn(*s, dtype=torch.bfloat16) * 0.05)(K, D, D) * scale),
        "gn_gamma": _w((lambda *s: torch.randn(*s, dtype=torch.bfloat16) * 0.05)(D) * 0.1 + 1.0),
        "gn_beta": _w((lambda *s: torch.randn(*s, dtype=torch.bfloat16) * 0.05)(D) * 0.1),
    }

def reference(x, w, gn_gamma, gn_beta):
    B, T, D = x.shape
    K = w.shape[0]
    s = 2
    L = (T - K) // s + 1
    h = torch.einsum('blc,cd->bld', x[:, 0:s * L:s, :], w[0])
    for i in range(1, K):
        h = h + torch.einsum('blc,cd->bld', x[:, i:i + s * L:s, :], w[i])
    mu = torch.einsum('bld->bd', h)[:, None, :] / L
    var = torch.einsum('bld->bd', (h - mu) ** 2)[:, None, :] / L
    h = (h - mu) / torch.sqrt(var + 1e-5)
    h = h * gn_gamma[None, None, :] + gn_beta[None, None, :]
    return _gelu(h)
```

```asm
; @launch grid=(254,1,1) block=(512,1,1) lds=163840
.amdgcn_target "amdgcn-amd-amdhsa--gfx950"
.text
.globl standalone__self_sup_conv_stem_wavlm__speech_kernel
.p2align 8
.type standalone__self_sup_conv_stem_wavlm__speech_kernel,@function
standalone__self_sup_conv_stem_wavlm__speech_kernel:
    s_load_dwordx8 s[4:11], s[0:1], 0
    s_load_dwordx4 s[12:15], s[0:1], 32
    s_load_dwordx2 s[16:17], s[0:1], 48
    s_lshr_b32 s54, s2, 4
    s_lshl_b32 s54, s54, 3
    s_and_b32 s55, s2, 7
    s_add_u32 s48, s54, s55
    s_cmp_ge_u32 s48, 126
    s_cbranch_scc1 L_end
    v_lshrrev_b32 v1, 6, v0
    v_and_b32 v2, 63, v0
    v_readfirstlane_b32 s53, v1
    s_bfe_u32 s49, s2, 0x10003
    s_cmp_ge_u32 s48, 63
    s_cselect_b32 s50, 1, 0
    s_mul_i32 s54, s50, 63
    s_sub_u32 s51, s48, s54
    s_cmp_lt_u32 s53, 4
    s_cbranch_scc1 L_compute
    s_sub_u32 s53, s53, 4
    v_lshrrev_b32 v5, 3, v2
    v_lshlrev_b32 v5, 10, v5
    s_lshl_b32 s54, s53, 1
    v_and_b32 v6, 7, v2
    v_xor_b32 v6, s54, v6
    v_lshl_add_u32 v3, v6, 4, v5
    v_xor_b32 v4, 16, v3
    v_lshrrev_b32 v6, 4, v2
    s_lshr_b32 s54, s53, 1
    s_lshl_b32 s54, s54, 2
    v_or_b32 v7, s54, v6
    v_bfe_u32 v8, v2, 1, 3
    v_xor_b32 v7, v7, v8
    v_lshlrev_b32 v5, 9, v6
    v_lshl_add_u32 v5, v7, 5, v5
    v_and_b32 v7, 1, v2
    v_lshl_add_u32 v5, v7, 4, v5
    s_bfe_u32 s54, s2, 0x50003
    s_lshl_b32 s54, s54, 2
    s_add_u32 s54, s54, s53
    s_mul_i32 s54, s54, 3072
    v_min_u32 v6, 47, v2
    v_lshl_add_u32 v6, v6, 6, s54
    s_mul_i32 s56, s50, 8192000
    s_mul_i32 s54, s51, 130048
    s_add_u32 s56, s56, s54
    s_lshl_b32 s54, s53, 15
    s_add_u32 s56, s56, s54
    s_lshl_b32 s54, s49, 9
    s_xor_b32 s55, s54, 512
    s_add_u32 s57, s56, s55
    s_add_u32 s56, s56, s54
    s_lshl_b32 s58, s53, 12
    s_add_u32 s59, s58, 49152
    s_lshl_b32 s60, s53, 11
    s_lshl_b32 s54, s49, 8
    s_add_u32 s60, s60, s54
    s_lshl_b32 s61, s53, 10
    s_add_u32 s61, s61, 81920
    s_lshr_b32 s54, s2, 4
    s_add_u32 s54, s54, 0
    s_and_b32 s54, s54, 3
    s_lshl_b32 s55, s54, 7
    s_add_u32 s64, s56, s55
    s_add_u32 s71, s57, s55
    s_lshl_b32 s55, s54, 15
    s_add_u32 s80, s60, s55
    s_lshr_b32 s54, s2, 4
    s_add_u32 s54, s54, 1
    s_and_b32 s54, s54, 3
    s_lshl_b32 s55, s54, 7
    s_add_u32 s65, s56, s55
    s_add_u32 s72, s57, s55
    s_lshl_b32 s55, s54, 15
    s_add_u32 s81, s60, s55
    s_lshr_b32 s54, s2, 4
    s_add_u32 s54, s54, 2
    s_and_b32 s54, s54, 3
    s_lshl_b32 s55, s54, 7
    s_add_u32 s66, s56, s55
    s_add_u32 s73, s57, s55
    s_lshl_b32 s55, s54, 15
    s_add_u32 s82, s60, s55
    s_lshr_b32 s54, s2, 4
    s_add_u32 s54, s54, 3
    s_and_b32 s54, s54, 3
    s_lshl_b32 s55, s54, 7
    s_add_u32 s67, s56, s55
    s_add_u32 s74, s57, s55
    s_lshl_b32 s55, s54, 15
    s_add_u32 s83, s60, s55
    s_waitcnt lgkmcnt(0)
    s_mov_b32 s20, s4
    s_and_b32 s21, s5, 0xffff
    s_mov_b32 s22, 16384000
    s_mov_b32 s23, 0x20000
    s_mov_b32 s24, s6
    s_and_b32 s25, s7, 0xffff
    s_mov_b32 s26, 393216
    s_mov_b32 s27, 0x20000
L_cls0:
    buffer_load_dword v8, v6, s[24:27], 0 offen
    s_add_u32 m0, s61, 0
    s_add_u32 s62, s80, 0
    buffer_load_dwordx4 v5, s[24:27], s62 offen lds
    s_add_u32 m0, s61, 4096
    s_add_u32 s62, s80, 8192
    buffer_load_dwordx4 v5, s[24:27], s62 offen lds
    s_add_u32 m0, s61, 8192
    s_add_u32 s62, s80, 131072
    buffer_load_dwordx4 v5, s[24:27], s62 offen lds
    s_add_u32 m0, s61, 12288
    s_add_u32 s62, s80, 139264
    buffer_load_dwordx4 v5, s[24:27], s62 offen lds
    s_add_u32 m0, s61, 16384
    s_add_u32 s62, s80, 262144
    buffer_load_dwordx4 v5, s[24:27], s62 offen lds
    s_add_u32 m0, s61, 20480
    s_add_u32 s62, s80, 270336
    buffer_load_dwordx4 v5, s[24:27], s62 offen lds
    s_add_u32 m0, s58, 0
    s_add_u32 s62, s64, 0
    buffer_load_dwordx4 v3, s[20:23], s62 offen lds
    s_add_u32 m0, s58, 1024
    s_add_u32 s62, s64, 8192
    buffer_load_dwordx4 v3, s[20:23], s62 offen lds
    s_add_u32 m0, s58, 2048
    s_add_u32 s62, s64, 16384
    buffer_load_dwordx4 v4, s[20:23], s62 offen lds
    s_add_u32 m0, s58, 3072
    s_add_u32 s62, s64, 24576
    buffer_load_dwordx4 v4, s[20:23], s62 offen lds
    s_add_u32 m0, s59, 0
    s_add_u32 s62, s71, 0
    buffer_load_dwordx4 v3, s[20:23], s62 offen lds
    s_add_u32 m0, s59, 1024
    s_add_u32 s62, s71, 8192
    buffer_load_dwordx4 v3, s[20:23], s62 offen lds
    s_add_u32 m0, s59, 2048
    s_add_u32 s62, s71, 16384
    buffer_load_dwordx4 v4, s[20:23], s62 offen lds
    s_lshl_b32 s52, s50, 1
    s_add_u32 s52, s52, s49
    s_cmp_eq_u32 s51, 62
    s_cselect_b32 s79, 2, 0
    s_sub_u32 s79, 127, s79
    s_lshl_b32 s86, s2, 8
    s_add_u32 s86, s86, 0x100000
    s_mov_b32 s28, s12
    s_and_b32 s29, s13, 0xffff
    s_mov_b32 s30, 8190976
    s_mov_b32 s31, 0x20000
    s_mov_b32 s32, s16
    s_and_b32 s33, s17, 0xffff
    s_mov_b32 s34, 294912
    s_mov_b32 s35, 0x20000
    s_mov_b32 s36, s14
    s_and_b32 s37, s15, 0xffff
    s_mov_b32 s38, 256
    s_mov_b32 s39, 0x20000
    s_mul_i32 s54, s50, 7999
    s_mul_i32 s55, s51, 127
    s_add_u32 s54, s54, s55
    s_lshl_b32 s75, s54, 9
    s_add_u32 s76, s75, 16384
    s_add_u32 s77, s75, 32768
    s_add_u32 s78, s75, 49152
    s_add_u32 m0, s59, 3072
    s_add_u32 s62, s71, 24576
    buffer_load_dwordx4 v4, s[20:23], s62 offen lds
    s_waitcnt vmcnt(0)
    s_barrier
    s_add_u32 m0, s61, 24576
    s_add_u32 s62, s80, 16384
    buffer_load_dwordx4 v5, s[24:27], s62 offen lds
    s_add_u32 m0, s61, 28672
    s_add_u32 s62, s80, 24576
    buffer_load_dwordx4 v5, s[24:27], s62 offen lds
    s_add_u32 m0, s61, 32768
    s_add_u32 s62, s80, 147456
    buffer_load_dwordx4 v5, s[24:27], s62 offen lds
    s_add_u32 m0, s61, 36864
    s_add_u32 s62, s80, 155648
    buffer_load_dwordx4 v5, s[24:27], s62 offen lds
    s_add_u32 m0, s61, 40960
    s_add_u32 s62, s80, 278528
    buffer_load_dwordx4 v5, s[24:27], s62 offen lds
    s_add_u32 m0, s61, 45056
    s_add_u32 s62, s80, 286720
    buffer_load_dwordx4 v5, s[24:27], s62 offen lds
    s_add_u32 m0, s58, 16384
    s_add_u32 s62, s65, 0
    buffer_load_dwordx4 v3, s[20:23], s62 offen lds
    s_add_u32 m0, s58, 17408
    s_add_u32 s62, s65, 8192
    buffer_load_dwordx4 v3, s[20:23], s62 offen lds
    s_add_u32 m0, s58, 18432
    s_add_u32 s62, s65, 16384
    buffer_load_dwordx4 v4, s[20:23], s62 offen lds
    s_add_u32 m0, s58, 19456
    s_add_u32 s62, s65, 24576
    buffer_load_dwordx4 v4, s[20:23], s62 offen lds
    s_add_u32 m0, s61, 49152
    s_add_u32 s62, s81, 0
    buffer_load_dwordx4 v5, s[24:27], s62 offen lds
    s_add_u32 m0, s61, 53248
    s_add_u32 s62, s81, 8192
    buffer_load_dwordx4 v5, s[24:27], s62 offen lds
    s_cmp_lg_u32 s53, 3
    s_cselect_b32 s91, 1, 0
    s_cbranch_scc1 L_sn_1
    s_lshl_b32 s54, s52, 16
    s_lshl_b32 s55, s51, 8
    s_add_u32 s54, s54, s55
    v_lshrrev_b32 v24, 4, v2
    v_lshlrev_b32 v24, 14, v24
    v_and_b32 v25, 15, v2
    v_lshl_add_u32 v24, v25, 4, v24
    v_mov_b32 v28, -1
    v_mov_b32 v29, -1
    v_mov_b32 v30, -1
    v_mov_b32 v31, -1
    buffer_store_dwordx4 v[28:31], v24, s[32:35], s54 offen sc1
    buffer_load_dwordx2 v[26:27], off, s[36:39], 0 sc1
L_sn_1:
    v_min_u32 v18, 62, v2
    s_lshl_b32 s54, s52, 13
    s_add_u32 s54, s54, 262144
    v_lshl_add_u32 v18, v18, 7, s54
    s_waitcnt vmcnt(6)
    s_barrier
    s_add_u32 m0, s61, 57344
    s_add_u32 s62, s81, 131072
    buffer_load_dwordx4 v5, s[24:27], s62 offen lds
    s_add_u32 m0, s61, 61440
    s_add_u32 s62, s81, 139264
    buffer_load_dwordx4 v5, s[24:27], s62 offen lds
    s_add_u32 m0, s61, 65536
    s_add_u32 s62, s81, 262144
    buffer_load_dwordx4 v5, s[24:27], s62 offen lds
    s_add_u32 m0, s61, 69632
    s_add_u32 s62, s81, 270336
    buffer_load_dwordx4 v5, s[24:27], s62 offen lds
    s_add_u32 m0, s59, 16384
    s_add_u32 s62, s72, 0
    buffer_load_dwordx4 v3, s[20:23], s62 offen lds
    s_add_u32 m0, s59, 17408
    s_add_u32 s62, s72, 8192
    buffer_load_dwordx4 v3, s[20:23], s62 offen lds
    s_add_u32 m0, s59, 18432
    s_add_u32 s62, s72, 16384
    buffer_load_dwordx4 v4, s[20:23], s62 offen lds
    s_add_u32 m0, s59, 19456
    s_add_u32 s62, s72, 24576
    buffer_load_dwordx4 v4, s[20:23], s62 offen lds
    s_add_u32 m0, s61, 73728
    s_add_u32 s62, s81, 16384
    buffer_load_dwordx4 v5, s[24:27], s62 offen lds
    s_add_u32 m0, s61, 77824
    s_add_u32 s62, s81, 24576
    buffer_load_dwordx4 v5, s[24:27], s62 offen lds
    s_cmp_lg_u32 s91, 0
    s_cbranch_scc1 L_pt_2
L_ptt_3:
    s_waitcnt vmcnt(10)
    v_readfirstlane_b32 s54, v26
    s_cmp_eq_u32 s54, 0
    s_cbranch_scc1 L_pta_4
    s_lshl_b32 s54, s52, 6
    s_add_u32 s54, s54, s51
    s_lshl_b32 s54, s54, 7
    s_add_u32 s54, s54, 262144
    s_mov_b64 exec, 1
    buffer_store_dwordx2 v[26:27], off, s[32:35], s54 sc1
    s_mov_b64 exec, -1
    s_mov_b32 s91, 1
    s_branch L_pt_2
L_pta_4:
    buffer_load_dwordx2 v[26:27], off, s[36:39], 0 sc1
L_pt_2:
    s_waitcnt vmcnt(2)
    s_barrier
    s_add_u32 m0, s61, 0
    s_add_u32 s62, s81, 147456
    buffer_load_dwordx4 v5, s[24:27], s62 offen lds
    s_add_u32 m0, s61, 4096
    s_add_u32 s62, s81, 155648
    buffer_load_dwordx4 v5, s[24:27], s62 offen lds
    s_add_u32 m0, s61, 8192
    s_add_u32 s62, s81, 278528
    buffer_load_dwordx4 v5, s[24:27], s62 offen lds
    s_add_u32 m0, s61, 12288
    s_add_u32 s62, s81, 286720
    buffer_load_dwordx4 v5, s[24:27], s62 offen lds
    s_add_u32 m0, s58, 32768
    s_add_u32 s62, s66, 0
    buffer_load_dwordx4 v3, s[20:23], s62 offen lds
    s_add_u32 m0, s58, 33792
    s_add_u32 s62, s66, 8192
    buffer_load_dwordx4 v3, s[20:23], s62 offen lds
    s_add_u32 m0, s58, 34816
    s_add_u32 s62, s66, 16384
    buffer_load_dwordx4 v4, s[20:23], s62 offen lds
    s_add_u32 m0, s58, 35840
    s_add_u32 s62, s66, 24576
    buffer_load_dwordx4 v4, s[20:23], s62 offen lds
    s_add_u32 m0, s61, 16384
    s_add_u32 s62, s82, 0
    buffer_load_dwordx4 v5, s[24:27], s62 offen lds
    s_add_u32 m0, s61, 20480
    s_add_u32 s62, s82, 8192
    buffer_load_dwordx4 v5, s[24:27], s62 offen lds
    s_cmp_lg_u32 s91, 0
    s_cbranch_scc1 L_pt_5
L_ptt_6:
    s_waitcnt vmcnt(10)
    v_readfirstlane_b32 s54, v26
    s_cmp_eq_u32 s54, 0
    s_cbranch_scc1 L_pta_7
    s_lshl_b32 s54, s52, 6
    s_add_u32 s54, s54, s51
    s_lshl_b32 s54, s54, 7
    s_add_u32 s54, s54, 262144
    s_mov_b64 exec, 1
    buffer_store_dwordx2 v[26:27], off, s[32:35], s54 sc1
    s_mov_b64 exec, -1
    s_mov_b32 s91, 1
    s_branch L_pt_5
L_pta_7:
    buffer_load_dwordx2 v[26:27], off, s[36:39], 0 sc1
L_pt_5:
    s_waitcnt vmcnt(6)
    s_barrier
    s_add_u32 m0, s61, 24576
    s_add_u32 s62, s82, 131072
    buffer_load_dwordx4 v5, s[24:27], s62 offen lds
    s_add_u32 m0, s61, 28672
    s_add_u32 s62, s82, 139264
    buffer_load_dwordx4 v5, s[24:27], s62 offen lds
    s_add_u32 m0, s61, 32768
    s_add_u32 s62, s82, 262144
    buffer_load_dwordx4 v5, s[24:27], s62 offen lds
    s_add_u32 m0, s61, 36864
    s_add_u32 s62, s82, 270336
    buffer_load_dwordx4 v5, s[24:27], s62 offen lds
    s_add_u32 m0, s59, 0
    s_add_u32 s62, s73, 0
    buffer_load_dwordx4 v3, s[20:23], s62 offen lds
    s_add_u32 m0, s59, 1024
    s_add_u32 s62, s73, 8192
    buffer_load_dwordx4 v3, s[20:23], s62 offen lds
    s_add_u32 m0, s59, 2048
    s_add_u32 s62, s73, 16384
    buffer_load_dwordx4 v4, s[20:23], s62 offen lds
    s_add_u32 m0, s59, 3072
    s_add_u32 s62, s73, 24576
    buffer_load_dwordx4 v4, s[20:23], s62 offen lds
    s_add_u32 m0, s61, 40960
    s_add_u32 s62, s82, 16384
    buffer_load_dwordx4 v5, s[24:27], s62 offen lds
    s_add_u32 m0, s61, 45056
    s_add_u32 s62, s82, 24576
    buffer_load_dwordx4 v5, s[24:27], s62 offen lds
    s_cmp_lg_u32 s91, 0
    s_cbranch_scc1 L_pt_8
L_ptt_9:
    s_waitcnt vmcnt(10)
    v_readfirstlane_b32 s54, v26
    s_cmp_eq_u32 s54, 0
    s_cbranch_scc1 L_pta_10
    s_lshl_b32 s54, s52, 6
    s_add_u32 s54, s54, s51
    s_lshl_b32 s54, s54, 7
    s_add_u32 s54, s54, 262144
    s_mov_b64 exec, 1
    buffer_store_dwordx2 v[26:27], off, s[32:35], s54 sc1
    s_mov_b64 exec, -1
    s_mov_b32 s91, 1
    s_branch L_pt_8
L_pta_10:
    buffer_load_dwordx2 v[26:27], off, s[36:39], 0 sc1
L_pt_8:
    s_waitcnt vmcnt(2)
    s_barrier
    s_add_u32 m0, s61, 49152
    s_add_u32 s62, s82, 147456
    buffer_load_dwordx4 v5, s[24:27], s62 offen lds
    s_add_u32 m0, s61, 53248
    s_add_u32 s62, s82, 155648
    buffer_load_dwordx4 v5, s[24:27], s62 offen lds
    s_add_u32 m0, s61, 57344
    s_add_u32 s62, s82, 278528
    buffer_load_dwordx4 v5, s[24:27], s62 offen lds
    s_add_u32 m0, s61, 61440
    s_add_u32 s62, s82, 286720
    buffer_load_dwordx4 v5, s[24:27], s62 offen lds
    s_add_u32 m0, s58, 0
    s_add_u32 s62, s67, 0
    buffer_load_dwordx4 v3, s[20:23], s62 offen lds
    s_add_u32 m0, s58, 1024
    s_add_u32 s62, s67, 8192
    buffer_load_dwordx4 v3, s[20:23], s62 offen lds
    s_add_u32 m0, s58, 2048
    s_add_u32 s62, s67, 16384
    buffer_load_dwordx4 v4, s[20:23], s62 offen lds
    s_add_u32 m0, s58, 3072
    s_add_u32 s62, s67, 24576
    buffer_load_dwordx4 v4, s[20:23], s62 offen lds
    s_add_u32 m0, s61, 65536
    s_add_u32 s62, s83, 0
    buffer_load_dwordx4 v5, s[24:27], s62 offen lds
    s_add_u32 m0, s61, 69632
    s_add_u32 s62, s83, 8192
    buffer_load_dwordx4 v5, s[24:27], s62 offen lds
    s_cmp_lg_u32 s91, 0
    s_cbranch_scc1 L_pt_11
L_ptt_12:
    s_waitcnt vmcnt(10)
    v_readfirstlane_b32 s54, v26
    s_cmp_eq_u32 s54, 0
    s_cbranch_scc1 L_pta_13
    s_lshl_b32 s54, s52, 6
    s_add_u32 s54, s54, s51
    s_lshl_b32 s54, s54, 7
    s_add_u32 s54, s54, 262144
    s_mov_b64 exec, 1
    buffer_store_dwordx2 v[26:27], off, s[32:35], s54 sc1
    s_mov_b64 exec, -1
    s_mov_b32 s91, 1
    s_branch L_pt_11
L_pta_13:
    buffer_load_dwordx2 v[26:27], off, s[36:39], 0 sc1
L_pt_11:
    s_waitcnt vmcnt(6)
    s_barrier
    s_add_u32 m0, s61, 73728
    s_add_u32 s62, s83, 131072
    buffer_load_dwordx4 v5, s[24:27], s62 offen lds
    s_add_u32 m0, s61, 77824
    s_add_u32 s62, s83, 139264
    buffer_load_dwordx4 v5, s[24:27], s62 offen lds
    s_add_u32 m0, s61, 0
    s_add_u32 s62, s83, 262144
    buffer_load_dwordx4 v5, s[24:27], s62 offen lds
    s_add_u32 m0, s61, 4096
    s_add_u32 s62, s83, 270336
    buffer_load_dwordx4 v5, s[24:27], s62 offen lds
    s_add_u32 m0, s59, 16384
    s_add_u32 s62, s74, 0
    buffer_load_dwordx4 v3, s[20:23], s62 offen lds
    s_add_u32 m0, s59, 17408
    s_add_u32 s62, s74, 8192
    buffer_load_dwordx4 v3, s[20:23], s62 offen lds
    s_add_u32 m0, s59, 18432
    s_add_u32 s62, s74, 16384
    buffer_load_dwordx4 v4, s[20:23], s62 offen lds
    s_add_u32 m0, s59, 19456
    s_add_u32 s62, s74, 24576
    buffer_load_dwordx4 v4, s[20:23], s62 offen lds
    s_add_u32 m0, s61, 8192
    s_add_u32 s62, s83, 16384
    buffer_load_dwordx4 v5, s[24:27], s62 offen lds
    s_add_u32 m0, s61, 12288
    s_add_u32 s62, s83, 24576
    buffer_load_dwordx4 v5, s[24:27], s62 offen lds
    s_waitcnt vmcnt(2)
    s_barrier
    s_add_u32 m0, s61, 16384
    s_add_u32 s62, s83, 147456
    buffer_load_dwordx4 v5, s[24:27], s62 offen lds
    s_add_u32 m0, s61, 20480
    s_add_u32 s62, s83, 155648
    buffer_load_dwordx4 v5, s[24:27], s62 offen lds
    s_add_u32 m0, s61, 24576
    s_add_u32 s62, s83, 278528
    buffer_load_dwordx4 v5, s[24:27], s62 offen lds
    s_add_u32 m0, s61, 28672
    s_add_u32 s62, s83, 286720
    buffer_load_dwordx4 v5, s[24:27], s62 offen lds
    s_waitcnt vmcnt(0)
    s_barrier
L_ldone:
    s_cmp_lg_u32 s53, 3
    s_cbranch_scc1 L_cnt_ok
    s_cmp_lg_u32 s91, 0
    s_cbranch_scc1 L_pt_14
    s_mov_b32 s87, 0
L_ptt_15:
    s_waitcnt vmcnt(0)
    v_readfirstlane_b32 s54, v26
    s_cmp_eq_u32 s54, 0
    s_cbranch_scc1 L_pta_16
    s_lshl_b32 s54, s52, 6
    s_add_u32 s54, s54, s51
    s_lshl_b32 s54, s54, 7
    s_add_u32 s54, s54, 262144
    s_mov_b64 exec, 1
    buffer_store_dwordx2 v[26:27], off, s[32:35], s54 sc1
    s_mov_b64 exec, -1
    s_mov_b32 s91, 1
    s_branch L_pt_14
L_pta_16:
    buffer_load_dwordx2 v[26:27], off, s[36:39], 0 sc1
    s_add_u32 s87, s87, 1
    s_cmp_le_u32 s87, 200000
    s_cbranch_scc1 L_ptt_15
L_pt_14:
    s_mov_b32 s87, 0
L_cnt:
    buffer_load_dwordx2 v[16:17], v18, s[32:35], 0 offen sc1
    s_waitcnt vmcnt(0)
    v_cmp_ne_u64 vcc, v[16:17], v[26:27]
    s_cbranch_vccz L_cnt_ok
    s_add_u32 s87, s87, 1
    s_cmp_gt_u32 s87, 200000
    s_cbranch_scc1 L_cnt_ok
    s_sleep 4
    s_branch L_cnt
L_cnt_ok:
    s_waitcnt lgkmcnt(0)
    v_and_b32 v3, 15, v0
    v_lshrrev_b32 v4, 4, v0
    v_lshlrev_b32 v5, 1, v3
    v_lshrrev_b32 v6, 3, v3
    v_xor_b32 v5, v5, v6
    v_lshlrev_b32 v5, 4, v5
    v_lshl_add_u32 v5, v4, 9, v5
    v_xor_b32 v6, 16, v5
    s_lshl_b32 s54, s49, 8
    v_lshl_add_u32 v8, v4, 9, s54
    v_lshl_add_u32 v8, v3, 4, v8
    v_add_u32 v4, 96, v4
    v_cmp_gt_u32 vcc, s79, v4
    v_mov_b32 v9, 0x7ff00000
    v_lshlrev_b32 v10, 5, v3
    v_cndmask_b32 v9, v9, v8, vcc
    v_add_u32 v10, 65536, v10
    s_barrier
    s_barrier
    ds_read_b128 v[64:67], v5 offset:0
    ds_read_b128 v[68:71], v6 offset:0
    ds_read_b128 v[72:75], v5 offset:16384
    ds_read_b128 v[76:79], v6 offset:16384
    ds_read_b128 v[80:83], v5 offset:32768
    ds_read_b128 v[84:87], v6 offset:32768
    ds_read_b128 v[88:91], v5 offset:49152
    ds_read_b128 v[92:95], v6 offset:49152
    s_barrier
    s_branch L_epi
L_compute:
    s_cmp_lg_u32 s53, 3
    s_cbranch_scc1 L_ncp_17
    s_getpc_b64 s[90:91]
L_pcref:
    s_sub_u32 s90, s90, L_pcref-standalone__self_sup_conv_stem_wavlm__speech_kernel
    s_subb_u32 s91, s91, 0
    s_bfe_u32 s54, s2, 0x50003
    s_mul_i32 s54, s54, 640
    v_min_u32 v3, 9, v2
    v_lshl_add_u32 v3, v3, 6, s54
    v_min_u32 v3, L_codeend-standalone__self_sup_conv_stem_wavlm__speech_kernel-4, v3
    global_load_dword v61, v3, s[90:91]
L_ncp_17:
    v_bfe_u32 v3, v2, 2, 2
    v_and_b32 v4, 1, v2
    v_lshl_add_u32 v3, v3, 1, v4
    v_bfe_u32 v4, v2, 1, 1
    v_lshl_add_u32 v4, v3, 4, v4
    v_lshrrev_b32 v5, 4, v2
    v_xor_b32 v3, v3, v5
    v_lshlrev_b32 v3, 4, v3
    v_lshl_add_u32 v252, v4, 7, v3
    s_cmp_eq_u32 s49, 0
    s_mov_b32 s54, 0
    s_mov_b32 s55, 49152
    s_cselect_b32 s56, s54, s55
    s_cselect_b32 s60, s55, s54
    s_mov_b32 s54, 16384
    s_mov_b32 s55, 65536
    s_cselect_b32 s57, s54, s55
    s_cselect_b32 s61, s55, s54
    s_mov_b32 s54, 32768
    s_mov_b32 s55, 49152
    s_cselect_b32 s58, s54, s55
    s_cselect_b32 s62, s55, s54
    s_mov_b32 s54, 0
    s_mov_b32 s55, 65536
    s_cselect_b32 s59, s54, s55
    s_cselect_b32 s63, s55, s54
    v_add_u32 v40, s56, v252
    v_xor_b32 v41, 64, v40
    v_add_u32 v42, s60, v252
    v_xor_b32 v43, 64, v42
    v_add_u32 v248, s57, v252
    v_xor_b32 v249, 64, v248
    v_add_u32 v250, s61, v252
    v_xor_b32 v251, 64, v250
    v_bfe_u32 v3, v2, 2, 2
    v_lshl_add_u32 v4, v5, 3, v3
    v_lshlrev_b32 v4, 8, v4
    v_and_b32 v6, 1, v5
    v_lshl_add_u32 v3, v6, 2, v3
    s_lshl_b32 s54, s53, 1
    v_xor_b32 v3, s54, v3
    v_lshl_add_u32 v4, v3, 5, v4
    v_and_b32 v3, 3, v2
    v_lshl_add_u32 v4, v3, 3, v4
    v_add_u32 v44, 81920, v4
    v_xor_b32 v45, 32, v44
    v_add_u32 v253, 0x8000, v44
    v_add_u32 v60, 0x8000, v45
    v_and_b32 v3, 15, v2
    s_lshl_b32 s54, s53, 5
    v_add_u32 v3, s54, v3
    v_lshrrev_b32 v4, 2, v3
    v_bfe_u32 v6, v3, 6, 1
    v_xor_b32 v4, v4, v6
    v_lshlrev_b32 v4, 4, v4
    v_and_b32 v6, 3, v3
    v_lshl_add_u32 v4, v6, 2, v4
    v_lshl_add_u32 v49, v5, 14, v4
    v_add_u32 v50, 64, v49
    s_mov_b32 s64, 0
    s_mov_b32 s65, 0xffff0000
    s_mov_b32 s66, 0
    s_cmp_eq_u32 s51, 62
    s_cselect_b32 s67, s65, 0
    s_mov_b32 s68, 0xffff0000
    s_mov_b32 s69, 0
    s_waitcnt lgkmcnt(0)
    s_lshl_b32 s52, s50, 1
    s_add_u32 s52, s52, s49
    s_cmp_eq_u32 s51, 62
    s_cselect_b32 s79, 2, 0
    s_sub_u32 s79, 127, s79
    s_lshl_b32 s86, s2, 8
    s_add_u32 s86, s86, 0x100000
    s_mov_b32 s28, s12
    s_and_b32 s29, s13, 0xffff
    s_mov_b32 s30, 8190976
    s_mov_b32 s31, 0x20000
    s_mov_b32 s32, s16
    s_and_b32 s33, s17, 0xffff
    s_mov_b32 s34, 294912
    s_mov_b32 s35, 0x20000
    s_mov_b32 s36, s14
    s_and_b32 s37, s15, 0xffff
    s_mov_b32 s38, 256
    s_mov_b32 s39, 0x20000
    s_mul_i32 s54, s50, 7999
    s_mul_i32 s55, s51, 127
    s_add_u32 s54, s54, s55
    s_lshl_b32 s75, s54, 9
    s_add_u32 s76, s75, 16384
    s_add_u32 s77, s75, 32768
    s_add_u32 s78, s75, 49152
    s_lshl_b32 s70, s52, 2
    s_add_u32 s70, s70, s53
    s_lshl_b32 s70, s70, 14
    s_lshl_b32 s54, s51, 8
    s_add_u32 s54, s54, s70
    v_lshl_add_u32 v46, v2, 2, s54
    s_mov_b64 s[92:93], 0
    s_cmp_lg_u32 s53, 0
    s_cbranch_scc1 L_nosent
    s_cmp_lg_u32 s2, 0
    s_cbranch_scc1 L_nonon
    s_memrealtime s[92:93]
    v_lshlrev_b32 v3, 6, v2
    s_waitcnt lgkmcnt(0)
    s_or_b32 s92, s92, 1
    v_mov_b32 v240, s92
    v_mov_b32 v241, s93
    s_mov_b64 exec, 1
    buffer_store_dwordx2 v[240:241], off, s[36:39], 0 sc1
    s_mov_b64 exec, -1
L_nonon:
L_nosent:
    s_mov_b32 s90, s54
    s_mov_b32 s40, s8
    s_and_b32 s41, s9, 0xffff
    s_mov_b32 s42, 512
    s_mov_b32 s43, 0x20000
    s_mov_b32 s44, s10
    s_and_b32 s45, s11, 0xffff
    s_mov_b32 s46, 512
    s_mov_b32 s47, 0x20000
    s_add_u32 s71, s70, 0
    s_add_u32 s72, s70, 4096
    s_add_u32 s73, s70, 8192
    s_add_u32 s74, s70, 12288
    v_and_b32 v3, 7, v2
    v_lshlrev_b32 v3, 2, v3
    v_lshrrev_b32 v4, 4, v2
    v_add_u32 v3, v3, v4
    s_lshl_b32 s54, s53, 5
    v_add_u32 v3, s54, v3
    v_lshlrev_b32 v53, 2, v3
    v_add_u32 v53, 65536, v53
    s_lshl_b32 s54, s49, 7
    v_add_lshl_u32 v3, v3, s54, 1
    buffer_load_ushort v48, v3, s[44:47], 0 offen
    buffer_load_ushort v47, v3, s[40:43], 0 offen
    v_lshlrev_b32 v54, 4, v2
    v_cmp_gt_u32 vcc, 48, v2
    v_mov_b32 v245, 0x7ff00000
    s_nop 0
    v_cndmask_b32 v55, v245, v54, vcc
    s_cmp_lg_u32 s53, 0
    s_cselect_b32 s91, 1, 0
    s_barrier
    ds_read_b64_tr_b16 v[192:193], v44 offset:0
    ds_read_b64_tr_b16 v[194:195], v44 offset:1024
    ds_read_b64_tr_b16 v[196:197], v45 offset:0
    ds_read_b64_tr_b16 v[198:199], v45 offset:1024
    ds_read_b128 v[8:11], v40 offset:0
    ds_read_b128 v[12:15], v42 offset:0
    ds_read_b64_tr_b16 v[200:201], v44 offset:8192
    ds_read_b64_tr_b16 v[202:203], v44 offset:9216
    ds_read_b64_tr_b16 v[204:205], v45 offset:8192
    ds_read_b64_tr_b16 v[206:207], v45 offset:9216
    ds_read_b64_tr_b16 v[208:209], v44 offset:16384
    ds_read_b64_tr_b16 v[210:211], v44 offset:17408
    ds_read_b64_tr_b16 v[212:213], v45 offset:16384
    ds_read_b64_tr_b16 v[214:215], v45 offset:17408
    ds_read_b128 v[16:19], v40 offset:256
    ds_read_b128 v[20:23], v42 offset:256
    ds_read_b128 v[24:27], v40 offset:512
    ds_read_b128 v[28:31], v42 offset:512
    s_waitcnt lgkmcnt(12)
    v_mfma_f32_16x16x32_bf16 v[64:67], v[8:11], v[192:195], 0
    s_waitcnt lgkmcnt(10)
    v_mfma_f32_16x16x32_bf16 v[64:67], v[12:15], v[200:203], v[64:67]
    ds_read_b128 v[32:35], v40 offset:768
    s_waitcnt lgkmcnt(9)
    v_mfma_f32_16x16x32_bf16 v[96:99], v[12:15], v[204:207], 0
    v_mfma_f32_16x16x32_bf16 v[96:99], v[8:11], v[196:199], v[96:99]
    ds_read_b128 v[36:39], v42 offset:768
    s_waitcnt lgkmcnt(6)
    v_mfma_f32_16x16x32_bf16 v[160:163], v[8:11], v[212:215], 0
    v_mfma_f32_16x16x32_bf16 v[128:131], v[8:11], v[208:211], 0
    s_waitcnt lgkmcnt(4)
    v_mfma_f32_16x16x32_bf16 v[68:71], v[16:19], v[192:195], 0
    v_mfma_f32_16x16x32_bf16 v[68:71], v[20:23], v[200:203], v[68:71]
    ds_read_b128 v[8:11], v40 offset:1024
    v_mfma_f32_16x16x32_bf16 v[100:103], v[20:23], v[204:207], 0
    v_mfma_f32_16x16x32_bf16 v[100:103], v[16:19], v[196:199], v[100:103]
    ds_read_b128 v[12:15], v42 offset:1024
    v_mfma_f32_16x16x32_bf16 v[164:167], v[16:19], v[212:215], 0
    v_mfma_f32_16x16x32_bf16 v[132:135], v[16:19], v[208:211], 0
    s_waitcnt lgkmcnt(4)
    v_mfma_f32_16x16x32_bf16 v[72:75], v[24:27], v[192:195], 0
    v_mfma_f32_16x16x32_bf16 v[72:75], v[28:31], v[200:203], v[72:75]
    ds_read_b128 v[16:19], v40 offset:1280
    v_mfma_f32_16x16x32_bf16 v[104:107], v[28:31], v[204:207], 0
    v_mfma_f32_16x16x32_bf16 v[104:107], v[24:27], v[196:199], v[104:107]
    ds_read_b128 v[20:23], v42 offset:1280
    v_mfma_f32_16x16x32_bf16 v[168:171], v[24:27], v[212:215], 0
    v_mfma_f32_16x16x32_bf16 v[136:139], v[24:27], v[208:211], 0
    s_waitcnt lgkmcnt(4)
    v_mfma_f32_16x16x32_bf16 v[76:79], v[32:35], v[192:195], 0
    v_mfma_f32_16x16x32_bf16 v[76:79], v[36:39], v[200:203], v[76:79]
    s_barrier
    ds_read_b128 v[24:27], v40 offset:1536
    ds_read_b128 v[28:31], v42 offset:1536
    v_mfma_f32_16x16x32_bf16 v[108:111], v[36:39], v[204:207], 0
    v_mfma_f32_16x16x32_bf16 v[108:111], v[32:35], v[196:199], v[108:111]
    ds_read_b64_tr_b16 v[216:217], v44 offset:24576
    v_mfma_f32_16x16x32_bf16 v[172:175], v[32:35], v[212:215], 0
    ds_read_b64_tr_b16 v[218:219], v44 offset:25600
    v_mfma_f32_16x16x32_bf16 v[140:143], v[32:35], v[208:211], 0
    ds_read_b64_tr_b16 v[220:221], v45 offset:24576
    s_waitcnt lgkmcnt(7)
    v_mfma_f32_16x16x32_bf16 v[80:83], v[8:11], v[192:195], 0
    v_mfma_f32_16x16x32_bf16 v[80:83], v[12:15], v[200:203], v[80:83]
    ds_read_b128 v[32:35], v40 offset:1792
    ds_read_b128 v[36:39], v42 offset:1792
    v_mfma_f32_16x16x32_bf16 v[112:115], v[12:15], v[204:207], 0
    v_mfma_f32_16x16x32_bf16 v[112:115], v[8:11], v[196:199], v[112:115]
    ds_read_b64_tr_b16 v[222:223], v45 offset:25600
    v_mfma_f32_16x16x32_bf16 v[176:179], v[8:11], v[212:215], 0
    ds_read_b64_tr_b16 v[224:225], v253 offset:0
    v_mfma_f32_16x16x32_bf16 v[144:147], v[8:11], v[208:211], 0
    ds_read_b64_tr_b16 v[226:227], v253 offset:1024
    s_waitcnt lgkmcnt(10)
    v_mfma_f32_16x16x32_bf16 v[84:87], v[16:19], v[192:195], 0
    v_mfma_f32_16x16x32_bf16 v[84:87], v[20:23], v[200:203], v[84:87]
    ds_read_b128 v[8:11], v41 offset:0
    v_mfma_f32_16x16x32_bf16 v[116:119], v[20:23], v[204:207], 0
    v_mfma_f32_16x16x32_bf16 v[116:119], v[16:19], v[196:199], v[116:119]
    ds_read_b128 v[12:15], v43 offset:0
    v_mfma_f32_16x16x32_bf16 v[180:183], v[16:19], v[212:215], 0
    ds_read_b64_tr_b16 v[228:229], v60 offset:0
    v_mfma_f32_16x16x32_bf16 v[148:151], v[16:19], v[208:211], 0
    ds_read_b64_tr_b16 v[230:231], v60 offset:1024
    s_waitcnt lgkmcnt(12)
    v_mfma_f32_16x16x32_bf16 v[88:91], v[24:27], v[192:195], 0
    v_mfma_f32_16x16x32_bf16 v[88:91], v[28:31], v[200:203], v[88:91]
    ds_read_b128 v[16:19], v41 offset:256
    v_mfma_f32_16x16x32_bf16 v[120:123], v[28:31], v[204:207], 0
    v_mfma_f32_16x16x32_bf16 v[120:123], v[24:27], v[196:199], v[120:123]
    ds_read_b128 v[20:23], v43 offset:256
    v_mfma_f32_16x16x32_bf16 v[184:187], v[24:27], v[212:215], 0
    ds_read_b64_tr_b16 v[232:233], v253 offset:8192
    v_mfma_f32_16x16x32_bf16 v[152:155], v[24:27], v[208:211], 0
    ds_read_b64_tr_b16 v[234:235], v253 offset:9216
    s_waitcnt lgkmcnt(11)
    v_mfma_f32_16x16x32_bf16 v[92:95], v[32:35], v[192:195], 0
    v_mfma_f32_16x16x32_bf16 v[92:95], v[36:39], v[200:203], v[92:95]
    ds_read_b128 v[24:27], v41 offset:512
    v_mfma_f32_16x16x32_bf16 v[124:127], v[36:39], v[204:207], 0
    v_mfma_f32_16x16x32_bf16 v[124:127], v[32:35], v[196:199], v[124:127]
    ds_read_b128 v[28:31], v43 offset:512
    v_mfma_f32_16x16x32_bf16 v[188:191], v[32:35], v[212:215], 0
    ds_read_b64_tr_b16 v[236:237], v60 offset:8192
    v_mfma_f32_16x16x32_bf16 v[156:159], v[32:35], v[208:211], 0
    ds_read_b64_tr_b16 v[238:239], v60 offset:9216
    s_waitcnt lgkmcnt(10)
    v_mfma_f32_16x16x32_bf16 v[64:67], v[8:11], v[216:219], v[64:67]
    v_mfma_f32_16x16x32_bf16 v[64:67], v[12:15], v[224:227], v[64:67]
    ds_read_b128 v[32:35], v41 offset:768
    s_waitcnt lgkmcnt(9)
    v_mfma_f32_16x16x32_bf16 v[96:99], v[12:15], v[228:231], v[96:99]
    v_mfma_f32_16x16x32_bf16 v[96:99], v[8:11], v[220:223], v[96:99]
    ds_read_b128 v[36:39], v43 offset:768
    s_waitcnt lgkmcnt(2)
    v_mfma_f32_16x16x32_bf16 v[160:163], v[8:11], v[236:239], v[160:163]
    v_mfma_f32_16x16x32_bf16 v[128:131], v[8:11], v[232:235], v[128:131]
    v_mfma_f32_16x16x32_bf16 v[68:71], v[16:19], v[216:219], v[68:71]
    v_mfma_f32_16x16x32_bf16 v[68:71], v[20:23], v[224:227], v[68:71]
    ds_read_b128 v[8:11], v41 offset:1024
    v_mfma_f32_16x16x32_bf16 v[100:103], v[20:23], v[228:231], v[100:103]
    v_mfma_f32_16x16x32_bf16 v[100:103], v[16:19], v[220:223], v[100:103]
    ds_read_b128 v[12:15], v43 offset:1024
    v_mfma_f32_16x16x32_bf16 v[164:167], v[16:19], v[236:239], v[164:167]
    v_mfma_f32_16x16x32_bf16 v[132:135], v[16:19], v[232:235], v[132:135]
    v_mfma_f32_16x16x32_bf16 v[72:75], v[24:27], v[216:219], v[72:75]
    v_mfma_f32_16x16x32_bf16 v[72:75], v[28:31], v[224:227], v[72:75]
    ds_read_b128 v[16:19], v41 offset:1280
    v_mfma_f32_16x16x32_bf16 v[104:107], v[28:31], v[228:231], v[104:107]
    v_mfma_f32_16x16x32_bf16 v[104:107], v[24:27], v[220:223], v[104:107]
    ds_read_b128 v[20:23], v43 offset:1280
    v_mfma_f32_16x16x32_bf16 v[168:171], v[24:27], v[236:239], v[168:171]
    v_mfma_f32_16x16x32_bf16 v[136:139], v[24:27], v[232:235], v[136:139]
    s_waitcnt lgkmcnt(4)
    v_mfma_f32_16x16x32_bf16 v[76:79], v[32:35], v[216:219], v[76:79]
    v_mfma_f32_16x16x32_bf16 v[76:79], v[36:39], v[224:227], v[76:79]
    s_barrier
    ds_read_b128 v[24:27], v41 offset:1536
    ds_read_b128 v[28:31], v43 offset:1536
    v_mfma_f32_16x16x32_bf16 v[108:111], v[36:39], v[228:231], v[108:111]
    v_mfma_f32_16x16x32_bf16 v[108:111], v[32:35], v[220:223], v[108:111]
    ds_read_b64_tr_b16 v[192:193], v253 offset:16384
    v_mfma_f32_16x16x32_bf16 v[172:175], v[32:35], v[236:239], v[172:175]
    ds_read_b64_tr_b16 v[194:195], v253 offset:17408
    v_mfma_f32_16x16x32_bf16 v[140:143], v[32:35], v[232:235], v[140:143]
    ds_read_b64_tr_b16 v[196:197], v60 offset:16384
    s_waitcnt lgkmcnt(7)
    v_mfma_f32_16x16x32_bf16 v[80:83], v[8:11], v[216:219], v[80:83]
    v_mfma_f32_16x16x32_bf16 v[80:83], v[12:15], v[224:227], v[80:83]
    ds_read_b128 v[32:35], v41 offset:1792
    ds_read_b128 v[36:39], v43 offset:1792
    v_mfma_f32_16x16x32_bf16 v[112:115], v[12:15], v[228:231], v[112:115]
    v_mfma_f32_16x16x32_bf16 v[112:115], v[8:11], v[220:223], v[112:115]
    ds_read_b64_tr_b16 v[198:199], v60 offset:17408
    v_mfma_f32_16x16x32_bf16 v[176:179], v[8:11], v[236:239], v[176:179]
    ds_read_b64_tr_b16 v[200:201], v253 offset:24576
    v_mfma_f32_16x16x32_bf16 v[144:147], v[8:11], v[232:235], v[144:147]
    ds_read_b64_tr_b16 v[202:203], v253 offset:25600
    s_waitcnt lgkmcnt(10)
    v_mfma_f32_16x16x32_bf16 v[84:87], v[16:19], v[216:219], v[84:87]
    v_mfma_f32_16x16x32_bf16 v[84:87], v[20:23], v[224:227], v[84:87]
    ds_read_b128 v[8:11], v248 offset:0
    v_mfma_f32_16x16x32_bf16 v[116:119], v[20:23], v[228:231], v[116:119]
    v_mfma_f32_16x16x32_bf16 v[116:119], v[16:19], v[220:223], v[116:119]
    ds_read_b128 v[12:15], v250 offset:0
    v_mfma_f32_16x16x32_bf16 v[180:183], v[16:19], v[236:239], v[180:183]
    ds_read_b64_tr_b16 v[204:205], v60 offset:24576
    v_mfma_f32_16x16x32_bf16 v[148:151], v[16:19], v[232:235], v[148:151]
    ds_read_b64_tr_b16 v[206:207], v60 offset:25600
    s_waitcnt lgkmcnt(12)
    v_mfma_f32_16x16x32_bf16 v[88:91], v[24:27], v[216:219], v[88:91]
    v_mfma_f32_16x16x32_bf16 v[88:91], v[28:31], v[224:227], v[88:91]
    ds_read_b128 v[16:19], v248 offset:256
    v_mfma_f32_16x16x32_bf16 v[120:123], v[28:31], v[228:231], v[120:123]
    v_mfma_f32_16x16x32_bf16 v[120:123], v[24:27], v[220:223], v[120:123]
    ds_read_b128 v[20:23], v250 offset:256
    v_mfma_f32_16x16x32_bf16 v[184:187], v[24:27], v[236:239], v[184:187]
    ds_read_b64_tr_b16 v[208:209], v253 offset:32768
    v_mfma_f32_16x16x32_bf16 v[152:155], v[24:27], v[232:235], v[152:155]
    ds_read_b64_tr_b16 v[210:211], v253 offset:33792
    s_waitcnt lgkmcnt(11)
    v_mfma_f32_16x16x32_bf16 v[92:95], v[32:35], v[216:219], v[92:95]
    v_mfma_f32_16x16x32_bf16 v[92:95], v[36:39], v[224:227], v[92:95]
    ds_read_b128 v[24:27], v248 offset:512
    v_mfma_f32_16x16x32_bf16 v[124:127], v[36:39], v[228:231], v[124:127]
    v_mfma_f32_16x16x32_bf16 v[124:127], v[32:35], v[220:223], v[124:127]
    ds_read_b128 v[28:31], v250 offset:512
    v_mfma_f32_16x16x32_bf16 v[188:191], v[32:35], v[236:239], v[188:191]
    ds_read_b64_tr_b16 v[212:213], v60 offset:32768
    v_mfma_f32_16x16x32_bf16 v[156:159], v[32:35], v[232:235], v[156:159]
    ds_read_b64_tr_b16 v[214:215], v60 offset:33792
    v_add_u32 v40, s58, v252
    v_xor_b32 v41, 64, v40
    v_add_u32 v42, s62, v252
    v_xor_b32 v43, 64, v42
    s_waitcnt lgkmcnt(10)
    v_mfma_f32_16x16x32_bf16 v[64:67], v[8:11], v[192:195], v[64:67]
    v_mfma_f32_16x16x32_bf16 v[64:67], v[12:15], v[200:203], v[64:67]
    ds_read_b128 v[32:35], v248 offset:768
    s_waitcnt lgkmcnt(9)
    v_mfma_f32_16x16x32_bf16 v[96:99], v[12:15], v[204:207], v[96:99]
    v_mfma_f32_16x16x32_bf16 v[96:99], v[8:11], v[196:199], v[96:99]
    ds_read_b128 v[36:39], v250 offset:768
    s_waitcnt lgkmcnt(2)
    v_mfma_f32_16x16x32_bf16 v[160:163], v[8:11], v[212:215], v[160:163]
    v_mfma_f32_16x16x32_bf16 v[128:131], v[8:11], v[208:211], v[128:131]
    v_mfma_f32_16x16x32_bf16 v[68:71], v[16:19], v[192:195], v[68:71]
    v_mfma_f32_16x16x32_bf16 v[68:71], v[20:23], v[200:203], v[68:71]
    ds_read_b128 v[8:11], v248 offset:1024
    v_mfma_f32_16x16x32_bf16 v[100:103], v[20:23], v[204:207], v[100:103]
    v_mfma_f32_16x16x32_bf16 v[100:103], v[16:19], v[196:199], v[100:103]
    ds_read_b128 v[12:15], v250 offset:1024
    v_mfma_f32_16x16x32_bf16 v[164:167], v[16:19], v[212:215], v[164:167]
    v_mfma_f32_16x16x32_bf16 v[132:135], v[16:19], v[208:211], v[132:135]
    v_mfma_f32_16x16x32_bf16 v[72:75], v[24:27], v[192:195], v[72:75]
    v_mfma_f32_16x16x32_bf16 v[72:75], v[28:31], v[200:203], v[72:75]
    ds_read_b128 v[16:19], v248 offset:1280
    v_mfma_f32_16x16x32_bf16 v[104:107], v[28:31], v[204:207], v[104:107]
    v_mfma_f32_16x16x32_bf16 v[104:107], v[24:27], v[196:199], v[104:107]
    ds_read_b128 v[20:23], v250 offset:1280
    v_mfma_f32_16x16x32_bf16 v[168:171], v[24:27], v[212:215], v[168:171]
    v_mfma_f32_16x16x32_bf16 v[136:139], v[24:27], v[208:211], v[136:139]
    s_waitcnt lgkmcnt(4)
    v_mfma_f32_16x16x32_bf16 v[76:79], v[32:35], v[192:195], v[76:79]
    v_mfma_f32_16x16x32_bf16 v[76:79], v[36:39], v[200:203], v[76:79]
    s_barrier
    ds_read_b128 v[24:27], v248 offset:1536
    ds_read_b128 v[28:31], v250 offset:1536
    v_mfma_f32_16x16x32_bf16 v[108:111], v[36:39], v[204:207], v[108:111]
    v_mfma_f32_16x16x32_bf16 v[108:111], v[32:35], v[196:199], v[108:111]
    ds_read_b64_tr_b16 v[216:217], v253 offset:40960
    v_mfma_f32_16x16x32_bf16 v[172:175], v[32:35], v[212:215], v[172:175]
    ds_read_b64_tr_b16 v[218:219], v253 offset:41984
    v_mfma_f32_16x16x32_bf16 v[140:143], v[32:35], v[208:211], v[140:143]
    ds_read_b64_tr_b16 v[220:221], v60 offset:40960
    s_waitcnt lgkmcnt(7)
    v_mfma_f32_16x16x32_bf16 v[80:83], v[8:11], v[192:195], v[80:83]
    v_mfma_f32_16x16x32_bf16 v[80:83], v[12:15], v[200:203], v[80:83]
    ds_read_b128 v[32:35], v248 offset:1792
    ds_read_b128 v[36:39], v250 offset:1792
    v_mfma_f32_16x16x32_bf16 v[112:115], v[12:15], v[204:207], v[112:115]
    v_mfma_f32_16x16x32_bf16 v[112:115], v[8:11], v[196:199], v[112:115]
    ds_read_b64_tr_b16 v[222:223], v60 offset:41984
    v_mfma_f32_16x16x32_bf16 v[176:179], v[8:11], v[212:215], v[176:179]
    ds_read_b64_tr_b16 v[224:225], v44 offset:0
    v_mfma_f32_16x16x32_bf16 v[144:147], v[8:11], v[208:211], v[144:147]
    ds_read_b64_tr_b16 v[226:227], v44 offset:1024
    s_waitcnt lgkmcnt(10)
    v_mfma_f32_16x16x32_bf16 v[84:87], v[16:19], v[192:195], v[84:87]
    v_mfma_f32_16x16x32_bf16 v[84:87], v[20:23], v[200:203], v[84:87]
    ds_read_b128 v[8:11], v249 offset:0
    v_mfma_f32_16x16x32_bf16 v[116:119], v[20:23], v[204:207], v[116:119]
    v_mfma_f32_16x16x32_bf16 v[116:119], v[16:19], v[196:199], v[116:119]
    ds_read_b128 v[12:15], v251 offset:0
    v_mfma_f32_16x16x32_bf16 v[180:183], v[16:19], v[212:215], v[180:183]
    ds_read_b64_tr_b16 v[228:229], v45 offset:0
    v_mfma_f32_16x16x32_bf16 v[148:151], v[16:19], v[208:211], v[148:151]
    ds_read_b64_tr_b16 v[230:231], v45 offset:1024
    s_waitcnt lgkmcnt(12)
    v_mfma_f32_16x16x32_bf16 v[88:91], v[24:27], v[192:195], v[88:91]
    v_mfma_f32_16x16x32_bf16 v[88:91], v[28:31], v[200:203], v[88:91]
    ds_read_b128 v[16:19], v249 offset:256
    v_mfma_f32_16x16x32_bf16 v[120:123], v[28:31], v[204:207], v[120:123]
    v_mfma_f32_16x16x32_bf16 v[120:123], v[24:27], v[196:199], v[120:123]
    ds_read_b128 v[20:23], v251 offset:256
    v_mfma_f32_16x16x32_bf16 v[184:187], v[24:27], v[212:215], v[184:187]
    ds_read_b64_tr_b16 v[232:233], v44 offset:8192
    v_mfma_f32_16x16x32_bf16 v[152:155], v[24:27], v[208:211], v[152:155]
    ds_read_b64_tr_b16 v[234:235], v44 offset:9216
    s_waitcnt lgkmcnt(11)
    v_mfma_f32_16x16x32_bf16 v[92:95], v[32:35], v[192:195], v[92:95]
    v_mfma_f32_16x16x32_bf16 v[92:95], v[36:39], v[200:203], v[92:95]
    ds_read_b128 v[24:27], v249 offset:512
    v_mfma_f32_16x16x32_bf16 v[124:127], v[36:39], v[204:207], v[124:127]
    v_mfma_f32_16x16x32_bf16 v[124:127], v[32:35], v[196:199], v[124:127]
    ds_read_b128 v[28:31], v251 offset:512
    v_mfma_f32_16x16x32_bf16 v[188:191], v[32:35], v[212:215], v[188:191]
    ds_read_b64_tr_b16 v[236:237], v45 offset:8192
    v_mfma_f32_16x16x32_bf16 v[156:159], v[32:35], v[208:211], v[156:159]
    ds_read_b64_tr_b16 v[238:239], v45 offset:9216
    s_waitcnt lgkmcnt(10)
    v_mfma_f32_16x16x32_bf16 v[64:67], v[8:11], v[216:219], v[64:67]
    v_mfma_f32_16x16x32_bf16 v[64:67], v[12:15], v[224:227], v[64:67]
    ds_read_b128 v[32:35], v249 offset:768
    s_waitcnt lgkmcnt(9)
    v_mfma_f32_16x16x32_bf16 v[96:99], v[12:15], v[228:231], v[96:99]
    v_mfma_f32_16x16x32_bf16 v[96:99], v[8:11], v[220:223], v[96:99]
    ds_read_b128 v[36:39], v251 offset:768
    s_waitcnt lgkmcnt(2)
    v_mfma_f32_16x16x32_bf16 v[160:163], v[8:11], v[236:239], v[160:163]
    v_mfma_f32_16x16x32_bf16 v[128:131], v[8:11], v[232:235], v[128:131]
    v_mfma_f32_16x16x32_bf16 v[68:71], v[16:19], v[216:219], v[68:71]
    v_mfma_f32_16x16x32_bf16 v[68:71], v[20:23], v[224:227], v[68:71]
    ds_read_b128 v[8:11], v249 offset:1024
    v_mfma_f32_16x16x32_bf16 v[100:103], v[20:23], v[228:231], v[100:103]
    v_mfma_f32_16x16x32_bf16 v[100:103], v[16:19], v[220:223], v[100:103]
    ds_read_b128 v[12:15], v251 offset:1024
    v_mfma_f32_16x16x32_bf16 v[164:167], v[16:19], v[236:239], v[164:167]
    v_mfma_f32_16x16x32_bf16 v[132:135], v[16:19], v[232:235], v[132:135]
    v_mfma_f32_16x16x32_bf16 v[72:75], v[24:27], v[216:219], v[72:75]
    v_mfma_f32_16x16x32_bf16 v[72:75], v[28:31], v[224:227], v[72:75]
    ds_read_b128 v[16:19], v249 offset:1280
    v_mfma_f32_16x16x32_bf16 v[104:107], v[28:31], v[228:231], v[104:107]
    v_mfma_f32_16x16x32_bf16 v[104:107], v[24:27], v[220:223], v[104:107]
    ds_read_b128 v[20:23], v251 offset:1280
    v_mfma_f32_16x16x32_bf16 v[168:171], v[24:27], v[236:239], v[168:171]
    v_mfma_f32_16x16x32_bf16 v[136:139], v[24:27], v[232:235], v[136:139]
    s_waitcnt lgkmcnt(4)
    v_mfma_f32_16x16x32_bf16 v[76:79], v[32:35], v[216:219], v[76:79]
    v_mfma_f32_16x16x32_bf16 v[76:79], v[36:39], v[224:227], v[76:79]
    s_barrier
    ds_read_b128 v[24:27], v249 offset:1536
    ds_read_b128 v[28:31], v251 offset:1536
    v_mfma_f32_16x16x32_bf16 v[108:111], v[36:39], v[228:231], v[108:111]
    v_mfma_f32_16x16x32_bf16 v[108:111], v[32:35], v[220:223], v[108:111]
    ds_read_b64_tr_b16 v[192:193], v44 offset:16384
    v_mfma_f32_16x16x32_bf16 v[172:175], v[32:35], v[236:239], v[172:175]
    ds_read_b64_tr_b16 v[194:195], v44 offset:17408
    v_mfma_f32_16x16x32_bf16 v[140:143], v[32:35], v[232:235], v[140:143]
    ds_read_b64_tr_b16 v[196:197], v45 offset:16384
    s_waitcnt lgkmcnt(7)
    v_mfma_f32_16x16x32_bf16 v[80:83], v[8:11], v[216:219], v[80:83]
    v_mfma_f32_16x16x32_bf16 v[80:83], v[12:15], v[224:227], v[80:83]
    ds_read_b128 v[32:35], v249 offset:1792
    ds_read_b128 v[36:39], v251 offset:1792
    v_mfma_f32_16x16x32_bf16 v[112:115], v[12:15], v[228:231], v[112:115]
    v_mfma_f32_16x16x32_bf16 v[112:115], v[8:11], v[220:223], v[112:115]
    ds_read_b64_tr_b16 v[198:199], v45 offset:17408
    v_mfma_f32_16x16x32_bf16 v[176:179], v[8:11], v[236:239], v[176:179]
    ds_read_b64_tr_b16 v[200:201], v44 offset:24576
    v_mfma_f32_16x16x32_bf16 v[144:147], v[8:11], v[232:235], v[144:147]
    ds_read_b64_tr_b16 v[202:203], v44 offset:25600
    s_waitcnt lgkmcnt(10)
    v_mfma_f32_16x16x32_bf16 v[84:87], v[16:19], v[216:219], v[84:87]
    v_mfma_f32_16x16x32_bf16 v[84:87], v[20:23], v[224:227], v[84:87]
    ds_read_b128 v[8:11], v40 offset:0
    v_mfma_f32_16x16x32_bf16 v[116:119], v[20:23], v[228:231], v[116:119]
    v_mfma_f32_16x16x32_bf16 v[116:119], v[16:19], v[220:223], v[116:119]
    ds_read_b128 v[12:15], v42 offset:0
    v_mfma_f32_16x16x32_bf16 v[180:183], v[16:19], v[236:239], v[180:183]
    ds_read_b64_tr_b16 v[204:205], v45 offset:24576
    v_mfma_f32_16x16x32_bf16 v[148:151], v[16:19], v[232:235], v[148:151]
    ds_read_b64_tr_b16 v[206:207], v45 offset:25600
    s_waitcnt lgkmcnt(12)
    v_mfma_f32_16x16x32_bf16 v[88:91], v[24:27], v[216:219], v[88:91]
    v_mfma_f32_16x16x32_bf16 v[88:91], v[28:31], v[224:227], v[88:91]
    ds_read_b128 v[16:19], v40 offset:256
    v_mfma_f32_16x16x32_bf16 v[120:123], v[28:31], v[228:231], v[120:123]
    v_mfma_f32_16x16x32_bf16 v[120:123], v[24:27], v[220:223], v[120:123]
    ds_read_b128 v[20:23], v42 offset:256
    v_mfma_f32_16x16x32_bf16 v[184:187], v[24:27], v[236:239], v[184:187]
    ds_read_b64_tr_b16 v[208:209], v253 offset:0
    v_mfma_f32_16x16x32_bf16 v[152:155], v[24:27], v[232:235], v[152:155]
    ds_read_b64_tr_b16 v[210:211], v253 offset:1024
    s_waitcnt lgkmcnt(11)
    v_mfma_f32_16x16x32_bf16 v[92:95], v[32:35], v[216:219], v[92:95]
    v_mfma_f32_16x16x32_bf16 v[92:95], v[36:39], v[224:227], v[92:95]
    ds_read_b128 v[24:27], v40 offset:512
    v_mfma_f32_16x16x32_bf16 v[124:127], v[36:39], v[228:231], v[124:127]
    v_mfma_f32_16x16x32_bf16 v[124:127], v[32:35], v[220:223], v[124:127]
    ds_read_b128 v[28:31], v42 offset:512
    v_mfma_f32_16x16x32_bf16 v[188:191], v[32:35], v[236:239], v[188:191]
    ds_read_b64_tr_b16 v[212:213], v60 offset:0
    v_mfma_f32_16x16x32_bf16 v[156:159], v[32:35], v[232:235], v[156:159]
    ds_read_b64_tr_b16 v[214:215], v60 offset:1024
    v_add_u32 v248, s59, v252
    v_xor_b32 v249, 64, v248
    v_add_u32 v250, s63, v252
    v_xor_b32 v251, 64, v250
    s_waitcnt lgkmcnt(10)
    v_mfma_f32_16x16x32_bf16 v[64:67], v[8:11], v[192:195], v[64:67]
    v_mfma_f32_16x16x32_bf16 v[64:67], v[12:15], v[200:203], v[64:67]
    ds_read_b128 v[32:35], v40 offset:768
    s_waitcnt lgkmcnt(9)
    v_mfma_f32_16x16x32_bf16 v[96:99], v[12:15], v[204:207], v[96:99]
    v_mfma_f32_16x16x32_bf16 v[96:99], v[8:11], v[196:199], v[96:99]
    ds_read_b128 v[36:39], v42 offset:768
    s_waitcnt lgkmcnt(2)
    v_mfma_f32_16x16x32_bf16 v[160:163], v[8:11], v[212:215], v[160:163]
    v_mfma_f32_16x16x32_bf16 v[128:131], v[8:11], v[208:211], v[128:131]
    v_mfma_f32_16x16x32_bf16 v[68:71], v[16:19], v[192:195], v[68:71]
    v_mfma_f32_16x16x32_bf16 v[68:71], v[20:23], v[200:203], v[68:71]
    ds_read_b128 v[8:11], v40 offset:1024
    v_mfma_f32_16x16x32_bf16 v[100:103], v[20:23], v[204:207], v[100:103]
    v_mfma_f32_16x16x32_bf16 v[100:103], v[16:19], v[196:199], v[100:103]
    ds_read_b128 v[12:15], v42 offset:1024
    v_mfma_f32_16x16x32_bf16 v[164:167], v[16:19], v[212:215], v[164:167]
    v_mfma_f32_16x16x32_bf16 v[132:135], v[16:19], v[208:211], v[132:135]
    v_mfma_f32_16x16x32_bf16 v[72:75], v[24:27], v[192:195], v[72:75]
    v_mfma_f32_16x16x32_bf16 v[72:75], v[28:31], v[200:203], v[72:75]
    ds_read_b128 v[16:19], v40 offset:1280
    v_mfma_f32_16x16x32_bf16 v[104:107], v[28:31], v[204:207], v[104:107]
    v_mfma_f32_16x16x32_bf16 v[104:107], v[24:27], v[196:199], v[104:107]
    ds_read_b128 v[20:23], v42 offset:1280
    v_mfma_f32_16x16x32_bf16 v[168:171], v[24:27], v[212:215], v[168:171]
    v_mfma_f32_16x16x32_bf16 v[136:139], v[24:27], v[208:211], v[136:139]
    s_waitcnt lgkmcnt(4)
    v_mfma_f32_16x16x32_bf16 v[76:79], v[32:35], v[192:195], v[76:79]
    v_mfma_f32_16x16x32_bf16 v[76:79], v[36:39], v[200:203], v[76:79]
    s_barrier
    ds_read_b128 v[24:27], v40 offset:1536
    ds_read_b128 v[28:31], v42 offset:1536
    v_mfma_f32_16x16x32_bf16 v[108:111], v[36:39], v[204:207], v[108:111]
    v_mfma_f32_16x16x32_bf16 v[108:111], v[32:35], v[196:199], v[108:111]
    ds_read_b64_tr_b16 v[216:217], v253 offset:8192
    v_mfma_f32_16x16x32_bf16 v[172:175], v[32:35], v[212:215], v[172:175]
    ds_read_b64_tr_b16 v[218:219], v253 offset:9216
    v_mfma_f32_16x16x32_bf16 v[140:143], v[32:35], v[208:211], v[140:143]
    ds_read_b64_tr_b16 v[220:221], v60 offset:8192
    s_waitcnt lgkmcnt(7)
    v_mfma_f32_16x16x32_bf16 v[80:83], v[8:11], v[192:195], v[80:83]
    v_mfma_f32_16x16x32_bf16 v[80:83], v[12:15], v[200:203], v[80:83]
    ds_read_b128 v[32:35], v40 offset:1792
    ds_read_b128 v[36:39], v42 offset:1792
    v_mfma_f32_16x16x32_bf16 v[112:115], v[12:15], v[204:207], v[112:115]
    v_mfma_f32_16x16x32_bf16 v[112:115], v[8:11], v[196:199], v[112:115]
    ds_read_b64_tr_b16 v[222:223], v60 offset:9216
    v_mfma_f32_16x16x32_bf16 v[176:179], v[8:11], v[212:215], v[176:179]
    ds_read_b64_tr_b16 v[224:225], v253 offset:16384
    v_mfma_f32_16x16x32_bf16 v[144:147], v[8:11], v[208:211], v[144:147]
    ds_read_b64_tr_b16 v[226:227], v253 offset:17408
    s_waitcnt lgkmcnt(10)
    v_mfma_f32_16x16x32_bf16 v[84:87], v[16:19], v[192:195], v[84:87]
    v_mfma_f32_16x16x32_bf16 v[84:87], v[20:23], v[200:203], v[84:87]
    ds_read_b128 v[8:11], v41 offset:0
    v_mfma_f32_16x16x32_bf16 v[116:119], v[20:23], v[204:207], v[116:119]
    v_mfma_f32_16x16x32_bf16 v[116:119], v[16:19], v[196:199], v[116:119]
    ds_read_b128 v[12:15], v43 offset:0
    v_mfma_f32_16x16x32_bf16 v[180:183], v[16:19], v[212:215], v[180:183]
    ds_read_b64_tr_b16 v[228:229], v60 offset:16384
    v_mfma_f32_16x16x32_bf16 v[148:151], v[16:19], v[208:211], v[148:151]
    ds_read_b64_tr_b16 v[230:231], v60 offset:17408
    s_waitcnt lgkmcnt(12)
    v_mfma_f32_16x16x32_bf16 v[88:91], v[24:27], v[192:195], v[88:91]
    v_mfma_f32_16x16x32_bf16 v[88:91], v[28:31], v[200:203], v[88:91]
    ds_read_b128 v[16:19], v41 offset:256
    v_mfma_f32_16x16x32_bf16 v[120:123], v[28:31], v[204:207], v[120:123]
    v_mfma_f32_16x16x32_bf16 v[120:123], v[24:27], v[196:199], v[120:123]
    ds_read_b128 v[20:23], v43 offset:256
    v_mfma_f32_16x16x32_bf16 v[184:187], v[24:27], v[212:215], v[184:187]
    ds_read_b64_tr_b16 v[232:233], v253 offset:24576
    v_mfma_f32_16x16x32_bf16 v[152:155], v[24:27], v[208:211], v[152:155]
    ds_read_b64_tr_b16 v[234:235], v253 offset:25600
    s_waitcnt lgkmcnt(11)
    v_mfma_f32_16x16x32_bf16 v[92:95], v[32:35], v[192:195], v[92:95]
    v_mfma_f32_16x16x32_bf16 v[92:95], v[36:39], v[200:203], v[92:95]
    ds_read_b128 v[24:27], v41 offset:512
    v_mfma_f32_16x16x32_bf16 v[124:127], v[36:39], v[204:207], v[124:127]
    v_mfma_f32_16x16x32_bf16 v[124:127], v[32:35], v[196:199], v[124:127]
    ds_read_b128 v[28:31], v43 offset:512
    v_mfma_f32_16x16x32_bf16 v[188:191], v[32:35], v[212:215], v[188:191]
    ds_read_b64_tr_b16 v[236:237], v60 offset:24576
    v_mfma_f32_16x16x32_bf16 v[156:159], v[32:35], v[208:211], v[156:159]
    ds_read_b64_tr_b16 v[238:239], v60 offset:25600
    s_waitcnt lgkmcnt(10)
    v_mfma_f32_16x16x32_bf16 v[64:67], v[8:11], v[216:219], v[64:67]
    v_mfma_f32_16x16x32_bf16 v[64:67], v[12:15], v[224:227], v[64:67]
    ds_read_b128 v[32:35], v41 offset:768
    s_waitcnt lgkmcnt(9)
    v_mfma_f32_16x16x32_bf16 v[96:99], v[12:15], v[228:231], v[96:99]
    v_mfma_f32_16x16x32_bf16 v[96:99], v[8:11], v[220:223], v[96:99]
    ds_read_b128 v[36:39], v43 offset:768
    s_waitcnt lgkmcnt(2)
    v_mfma_f32_16x16x32_bf16 v[160:163], v[8:11], v[236:239], v[160:163]
    v_mfma_f32_16x16x32_bf16 v[128:131], v[8:11], v[232:235], v[128:131]
    v_mfma_f32_16x16x32_bf16 v[68:71], v[16:19], v[216:219], v[68:71]
    v_mfma_f32_16x16x32_bf16 v[68:71], v[20:23], v[224:227], v[68:71]
    ds_read_b128 v[8:11], v41 offset:1024
    v_mfma_f32_16x16x32_bf16 v[100:103], v[20:23], v[228:231], v[100:103]
    v_mfma_f32_16x16x32_bf16 v[100:103], v[16:19], v[220:223], v[100:103]
    ds_read_b128 v[12:15], v43 offset:1024
    v_mfma_f32_16x16x32_bf16 v[164:167], v[16:19], v[236:239], v[164:167]
    v_mfma_f32_16x16x32_bf16 v[132:135], v[16:19], v[232:235], v[132:135]
    v_mfma_f32_16x16x32_bf16 v[72:75], v[24:27], v[216:219], v[72:75]
    v_mfma_f32_16x16x32_bf16 v[72:75], v[28:31], v[224:227], v[72:75]
    ds_read_b128 v[16:19], v41 offset:1280
    v_mfma_f32_16x16x32_bf16 v[104:107], v[28:31], v[228:231], v[104:107]
    v_mfma_f32_16x16x32_bf16 v[104:107], v[24:27], v[220:223], v[104:107]
    ds_read_b128 v[20:23], v43 offset:1280
    v_mfma_f32_16x16x32_bf16 v[168:171], v[24:27], v[236:239], v[168:171]
    v_mfma_f32_16x16x32_bf16 v[136:139], v[24:27], v[232:235], v[136:139]
    s_waitcnt lgkmcnt(4)
    v_mfma_f32_16x16x32_bf16 v[76:79], v[32:35], v[216:219], v[76:79]
    v_mfma_f32_16x16x32_bf16 v[76:79], v[36:39], v[224:227], v[76:79]
    s_barrier
    ds_read_b128 v[24:27], v41 offset:1536
    ds_read_b128 v[28:31], v43 offset:1536
    v_mfma_f32_16x16x32_bf16 v[108:111], v[36:39], v[228:231], v[108:111]
    v_mfma_f32_16x16x32_bf16 v[108:111], v[32:35], v[220:223], v[108:111]
    ds_read_b64_tr_b16 v[192:193], v253 offset:32768
    v_mfma_f32_16x16x32_bf16 v[172:175], v[32:35], v[236:239], v[172:175]
    ds_read_b64_tr_b16 v[194:195], v253 offset:33792
    v_mfma_f32_16x16x32_bf16 v[140:143], v[32:35], v[232:235], v[140:143]
    ds_read_b64_tr_b16 v[196:197], v60 offset:32768
    s_waitcnt lgkmcnt(7)
    v_mfma_f32_16x16x32_bf16 v[80:83], v[8:11], v[216:219], v[80:83]
    v_mfma_f32_16x16x32_bf16 v[80:83], v[12:15], v[224:227], v[80:83]
    ds_read_b128 v[32:35], v41 offset:1792
    ds_read_b128 v[36:39], v43 offset:1792
    v_mfma_f32_16x16x32_bf16 v[112:115], v[12:15], v[228:231], v[112:115]
    v_mfma_f32_16x16x32_bf16 v[112:115], v[8:11], v[220:223], v[112:115]
    ds_read_b64_tr_b16 v[198:199], v60 offset:33792
    v_mfma_f32_16x16x32_bf16 v[176:179], v[8:11], v[236:239], v[176:179]
    ds_read_b64_tr_b16 v[200:201], v253 offset:40960
    v_mfma_f32_16x16x32_bf16 v[144:147], v[8:11], v[232:235], v[144:147]
    ds_read_b64_tr_b16 v[202:203], v253 offset:41984
    s_waitcnt lgkmcnt(10)
    v_mfma_f32_16x16x32_bf16 v[84:87], v[16:19], v[216:219], v[84:87]
    v_mfma_f32_16x16x32_bf16 v[84:87], v[20:23], v[224:227], v[84:87]
    ds_read_b128 v[8:11], v248 offset:0
    v_mfma_f32_16x16x32_bf16 v[116:119], v[20:23], v[228:231], v[116:119]
    v_mfma_f32_16x16x32_bf16 v[116:119], v[16:19], v[220:223], v[116:119]
    ds_read_b128 v[12:15], v250 offset:0
    v_mfma_f32_16x16x32_bf16 v[180:183], v[16:19], v[236:239], v[180:183]
    ds_read_b64_tr_b16 v[204:205], v60 offset:40960
    v_mfma_f32_16x16x32_bf16 v[148:151], v[16:19], v[232:235], v[148:151]
    ds_read_b64_tr_b16 v[206:207], v60 offset:41984
    s_waitcnt lgkmcnt(12)
    v_mfma_f32_16x16x32_bf16 v[88:91], v[24:27], v[216:219], v[88:91]
    v_mfma_f32_16x16x32_bf16 v[88:91], v[28:31], v[224:227], v[88:91]
    ds_read_b128 v[16:19], v248 offset:256
    v_mfma_f32_16x16x32_bf16 v[120:123], v[28:31], v[228:231], v[120:123]
    v_mfma_f32_16x16x32_bf16 v[120:123], v[24:27], v[220:223], v[120:123]
    ds_read_b128 v[20:23], v250 offset:256
    v_mfma_f32_16x16x32_bf16 v[184:187], v[24:27], v[236:239], v[184:187]
    ds_read_b64_tr_b16 v[208:209], v44 offset:0
    v_mfma_f32_16x16x32_bf16 v[152:155], v[24:27], v[232:235], v[152:155]
    ds_read_b64_tr_b16 v[210:211], v44 offset:1024
    s_waitcnt lgkmcnt(11)
    v_mfma_f32_16x16x32_bf16 v[92:95], v[32:35], v[216:219], v[92:95]
    v_mfma_f32_16x16x32_bf16 v[92:95], v[36:39], v[224:227], v[92:95]
    ds_read_b128 v[24:27], v248 offset:512
    v_mfma_f32_16x16x32_bf16 v[124:127], v[36:39], v[228:231], v[124:127]
    v_mfma_f32_16x16x32_bf16 v[124:127], v[32:35], v[220:223], v[124:127]
    ds_read_b128 v[28:31], v250 offset:512
    v_mfma_f32_16x16x32_bf16 v[188:191], v[32:35], v[236:239], v[188:191]
    ds_read_b64_tr_b16 v[212:213], v45 offset:0
    v_mfma_f32_16x16x32_bf16 v[156:159], v[32:35], v[232:235], v[156:159]
    ds_read_b64_tr_b16 v[214:215], v45 offset:1024
    s_waitcnt lgkmcnt(10)
    v_mfma_f32_16x16x32_bf16 v[64:67], v[8:11], v[192:195], v[64:67]
    v_mfma_f32_16x16x32_bf16 v[64:67], v[12:15], v[200:203], v[64:67]
    ds_read_b128 v[32:35], v248 offset:768
    s_waitcnt lgkmcnt(9)
    v_mfma_f32_16x16x32_bf16 v[96:99], v[12:15], v[204:207], v[96:99]
    v_mfma_f32_16x16x32_bf16 v[96:99], v[8:11], v[196:199], v[96:99]
    ds_read_b128 v[36:39], v250 offset:768
    s_waitcnt lgkmcnt(2)
    v_mfma_f32_16x16x32_bf16 v[160:163], v[8:11], v[212:215], v[160:163]
    v_mfma_f32_16x16x32_bf16 v[128:131], v[8:11], v[208:211], v[128:131]
    v_mfma_f32_16x16x32_bf16 v[68:71], v[16:19], v[192:195], v[68:71]
    v_mfma_f32_16x16x32_bf16 v[68:71], v[20:23], v[200:203], v[68:71]
    ds_read_b128 v[8:11], v248 offset:1024
    v_mfma_f32_16x16x32_bf16 v[100:103], v[20:23], v[204:207], v[100:103]
    v_mfma_f32_16x16x32_bf16 v[100:103], v[16:19], v[196:199], v[100:103]
    ds_read_b128 v[12:15], v250 offset:1024
    v_mfma_f32_16x16x32_bf16 v[164:167], v[16:19], v[212:215], v[164:167]
    v_mfma_f32_16x16x32_bf16 v[132:135], v[16:19], v[208:211], v[132:135]
    v_mfma_f32_16x16x32_bf16 v[72:75], v[24:27], v[192:195], v[72:75]
    v_mfma_f32_16x16x32_bf16 v[72:75], v[28:31], v[200:203], v[72:75]
    ds_read_b128 v[16:19], v248 offset:1280
    v_mfma_f32_16x16x32_bf16 v[104:107], v[28:31], v[204:207], v[104:107]
    v_mfma_f32_16x16x32_bf16 v[104:107], v[24:27], v[196:199], v[104:107]
    ds_read_b128 v[20:23], v250 offset:1280
    v_mfma_f32_16x16x32_bf16 v[168:171], v[24:27], v[212:215], v[168:171]
    v_mfma_f32_16x16x32_bf16 v[136:139], v[24:27], v[208:211], v[136:139]
    s_waitcnt lgkmcnt(4)
    v_mfma_f32_16x16x32_bf16 v[76:79], v[32:35], v[192:195], v[76:79]
    v_mfma_f32_16x16x32_bf16 v[76:79], v[36:39], v[200:203], v[76:79]
    s_barrier
    ds_read_b128 v[24:27], v248 offset:1536
    ds_read_b128 v[28:31], v250 offset:1536
    v_mfma_f32_16x16x32_bf16 v[108:111], v[36:39], v[204:207], v[108:111]
    v_mfma_f32_16x16x32_bf16 v[108:111], v[32:35], v[196:199], v[108:111]
    ds_read_b64_tr_b16 v[216:217], v44 offset:8192
    v_mfma_f32_16x16x32_bf16 v[172:175], v[32:35], v[212:215], v[172:175]
    ds_read_b64_tr_b16 v[218:219], v44 offset:9216
    v_mfma_f32_16x16x32_bf16 v[140:143], v[32:35], v[208:211], v[140:143]
    ds_read_b64_tr_b16 v[220:221], v45 offset:8192
    s_waitcnt lgkmcnt(7)
    v_mfma_f32_16x16x32_bf16 v[80:83], v[8:11], v[192:195], v[80:83]
    v_mfma_f32_16x16x32_bf16 v[80:83], v[12:15], v[200:203], v[80:83]
    ds_read_b128 v[32:35], v248 offset:1792
    ds_read_b128 v[36:39], v250 offset:1792
    v_mfma_f32_16x16x32_bf16 v[112:115], v[12:15], v[204:207], v[112:115]
    v_mfma_f32_16x16x32_bf16 v[112:115], v[8:11], v[196:199], v[112:115]
    ds_read_b64_tr_b16 v[222:223], v45 offset:9216
    v_mfma_f32_16x16x32_bf16 v[176:179], v[8:11], v[212:215], v[176:179]
    ds_read_b64_tr_b16 v[224:225], v44 offset:16384
    v_mfma_f32_16x16x32_bf16 v[144:147], v[8:11], v[208:211], v[144:147]
    ds_read_b64_tr_b16 v[226:227], v44 offset:17408
    s_waitcnt lgkmcnt(10)
    v_mfma_f32_16x16x32_bf16 v[84:87], v[16:19], v[192:195], v[84:87]
    v_mfma_f32_16x16x32_bf16 v[84:87], v[20:23], v[200:203], v[84:87]
    ds_read_b128 v[8:11], v249 offset:0
    v_mfma_f32_16x16x32_bf16 v[116:119], v[20:23], v[204:207], v[116:119]
    v_mfma_f32_16x16x32_bf16 v[116:119], v[16:19], v[196:199], v[116:119]
    ds_read_b128 v[12:15], v251 offset:0
    v_mfma_f32_16x16x32_bf16 v[180:183], v[16:19], v[212:215], v[180:183]
    ds_read_b64_tr_b16 v[228:229], v45 offset:16384
    v_mfma_f32_16x16x32_bf16 v[148:151], v[16:19], v[208:211], v[148:151]
    ds_read_b64_tr_b16 v[230:231], v45 offset:17408
    s_waitcnt lgkmcnt(12)
    v_mfma_f32_16x16x32_bf16 v[88:91], v[24:27], v[192:195], v[88:91]
    v_mfma_f32_16x16x32_bf16 v[88:91], v[28:31], v[200:203], v[88:91]
    ds_read_b128 v[16:19], v249 offset:256
    v_mfma_f32_16x16x32_bf16 v[120:123], v[28:31], v[204:207], v[120:123]
    v_mfma_f32_16x16x32_bf16 v[120:123], v[24:27], v[196:199], v[120:123]
    ds_read_b128 v[20:23], v251 offset:256
    v_mfma_f32_16x16x32_bf16 v[184:187], v[24:27], v[212:215], v[184:187]
    ds_read_b64_tr_b16 v[232:233], v44 offset:24576
    v_mfma_f32_16x16x32_bf16 v[152:155], v[24:27], v[208:211], v[152:155]
    ds_read_b64_tr_b16 v[234:235], v44 offset:25600
    s_waitcnt lgkmcnt(11)
    v_mfma_f32_16x16x32_bf16 v[92:95], v[32:35], v[192:195], v[92:95]
    v_mfma_f32_16x16x32_bf16 v[92:95], v[36:39], v[200:203], v[92:95]
    ds_read_b128 v[24:27], v249 offset:512
    v_mfma_f32_16x16x32_bf16 v[124:127], v[36:39], v[204:207], v[124:127]
    v_mfma_f32_16x16x32_bf16 v[124:127], v[32:35], v[196:199], v[124:127]
    ds_read_b128 v[28:31], v251 offset:512
    v_mfma_f32_16x16x32_bf16 v[188:191], v[32:35], v[212:215], v[188:191]
    ds_read_b64_tr_b16 v[236:237], v45 offset:24576
    v_mfma_f32_16x16x32_bf16 v[156:159], v[32:35], v[208:211], v[156:159]
    ds_read_b64_tr_b16 v[238:239], v45 offset:25600
    s_waitcnt lgkmcnt(10)
    v_mfma_f32_16x16x32_bf16 v[64:67], v[8:11], v[216:219], v[64:67]
    v_mfma_f32_16x16x32_bf16 v[64:67], v[12:15], v[224:227], v[64:67]
    ds_read_b128 v[32:35], v249 offset:768
    s_waitcnt lgkmcnt(9)
    v_mfma_f32_16x16x32_bf16 v[96:99], v[12:15], v[228:231], v[96:99]
    v_mfma_f32_16x16x32_bf16 v[96:99], v[8:11], v[220:223], v[96:99]
    ds_read_b128 v[36:39], v251 offset:768
    s_waitcnt lgkmcnt(2)
    v_mfma_f32_16x16x32_bf16 v[160:163], v[8:11], v[236:239], v[160:163]
    v_mfma_f32_16x16x32_bf16 v[128:131], v[8:11], v[232:235], v[128:131]
    v_mfma_f32_16x16x32_bf16 v[68:71], v[16:19], v[216:219], v[68:71]
    v_mfma_f32_16x16x32_bf16 v[68:71], v[20:23], v[224:227], v[68:71]
    ds_read_b128 v[8:11], v249 offset:1024
    v_mfma_f32_16x16x32_bf16 v[100:103], v[20:23], v[228:231], v[100:103]
    v_mfma_f32_16x16x32_bf16 v[100:103], v[16:19], v[220:223], v[100:103]
    ds_read_b128 v[12:15], v251 offset:1024
    v_mfma_f32_16x16x32_bf16 v[164:167], v[16:19], v[236:239], v[164:167]
    v_mfma_f32_16x16x32_bf16 v[132:135], v[16:19], v[232:235], v[132:135]
    v_mfma_f32_16x16x32_bf16 v[72:75], v[24:27], v[216:219], v[72:75]
    v_mfma_f32_16x16x32_bf16 v[72:75], v[28:31], v[224:227], v[72:75]
    ds_read_b128 v[16:19], v249 offset:1280
    v_mfma_f32_16x16x32_bf16 v[104:107], v[28:31], v[228:231], v[104:107]
    v_mfma_f32_16x16x32_bf16 v[104:107], v[24:27], v[220:223], v[104:107]
    ds_read_b128 v[20:23], v251 offset:1280
    v_mfma_f32_16x16x32_bf16 v[168:171], v[24:27], v[236:239], v[168:171]
    v_mfma_f32_16x16x32_bf16 v[136:139], v[24:27], v[232:235], v[136:139]
    s_waitcnt lgkmcnt(4)
    v_mfma_f32_16x16x32_bf16 v[76:79], v[32:35], v[216:219], v[76:79]
    v_mfma_f32_16x16x32_bf16 v[76:79], v[36:39], v[224:227], v[76:79]
    ds_read_b128 v[24:27], v249 offset:1536
    v_mfma_f32_16x16x32_bf16 v[108:111], v[36:39], v[228:231], v[108:111]
    v_mfma_f32_16x16x32_bf16 v[108:111], v[32:35], v[220:223], v[108:111]
    ds_read_b128 v[28:31], v251 offset:1536
    v_mfma_f32_16x16x32_bf16 v[172:175], v[32:35], v[236:239], v[172:175]
    v_mfma_f32_16x16x32_bf16 v[140:143], v[32:35], v[232:235], v[140:143]
    s_waitcnt lgkmcnt(4)
    v_mfma_f32_16x16x32_bf16 v[80:83], v[8:11], v[216:219], v[80:83]
    v_mfma_f32_16x16x32_bf16 v[80:83], v[12:15], v[224:227], v[80:83]
    ds_read_b128 v[32:35], v249 offset:1792
    v_mfma_f32_16x16x32_bf16 v[112:115], v[12:15], v[228:231], v[112:115]
    v_mfma_f32_16x16x32_bf16 v[112:115], v[8:11], v[220:223], v[112:115]
    ds_read_b128 v[36:39], v251 offset:1792
    v_mfma_f32_16x16x32_bf16 v[176:179], v[8:11], v[236:239], v[176:179]
    v_mfma_f32_16x16x32_bf16 v[144:147], v[8:11], v[232:235], v[144:147]
    s_waitcnt lgkmcnt(4)
    v_mfma_f32_16x16x32_bf16 v[84:87], v[16:19], v[216:219], v[84:87]
    v_mfma_f32_16x16x32_bf16 v[84:87], v[20:23], v[224:227], v[84:87]
    v_mfma_f32_16x16x32_bf16 v[116:119], v[20:23], v[228:231], v[116:119]
    v_mfma_f32_16x16x32_bf16 v[116:119], v[16:19], v[220:223], v[116:119]
    v_mfma_f32_16x16x32_bf16 v[180:183], v[16:19], v[236:239], v[180:183]
    v_mfma_f32_16x16x32_bf16 v[148:151], v[16:19], v[232:235], v[148:151]
    s_waitcnt lgkmcnt(2)
    v_mfma_f32_16x16x32_bf16 v[88:91], v[24:27], v[216:219], v[88:91]
    v_mfma_f32_16x16x32_bf16 v[88:91], v[28:31], v[224:227], v[88:91]
    v_mfma_f32_16x16x32_bf16 v[120:123], v[28:31], v[228:231], v[120:123]
    v_mfma_f32_16x16x32_bf16 v[120:123], v[24:27], v[220:223], v[120:123]
    v_mfma_f32_16x16x32_bf16 v[184:187], v[24:27], v[236:239], v[184:187]
    v_mfma_f32_16x16x32_bf16 v[152:155], v[24:27], v[232:235], v[152:155]
    s_waitcnt lgkmcnt(0)
    v_mfma_f32_16x16x32_bf16 v[92:95], v[32:35], v[216:219], v[92:95]
    v_mfma_f32_16x16x32_bf16 v[92:95], v[36:39], v[224:227], v[92:95]
    v_mfma_f32_16x16x32_bf16 v[124:127], v[36:39], v[228:231], v[124:127]
    v_mfma_f32_16x16x32_bf16 v[124:127], v[32:35], v[220:223], v[124:127]
    v_mfma_f32_16x16x32_bf16 v[188:191], v[32:35], v[236:239], v[188:191]
    v_mfma_f32_16x16x32_bf16 v[156:159], v[32:35], v[232:235], v[156:159]
    v_pk_add_f32 v[64:65], v[64:65], v[130:131]
    v_pk_add_f32 v[96:97], v[96:97], v[162:163]
    v_mov_b32 v240, v128
    v_mov_b32 v242, v160
    v_pk_add_f32 v[66:67], v[66:67], v[132:133]
    v_pk_add_f32 v[98:99], v[98:99], v[164:165]
    v_pk_add_f32 v[68:69], v[68:69], v[134:135]
    v_pk_add_f32 v[100:101], v[100:101], v[166:167]
    v_pk_mul_f32 v[196:197], v[64:65], v[64:65]
    v_pk_mul_f32 v[204:205], v[96:97], v[96:97]
    v_permlane16_swap_b32 v128, v240
    v_permlane16_swap_b32 v160, v242
    v_pk_add_f32 v[70:71], v[70:71], v[136:137]
    v_pk_add_f32 v[102:103], v[102:103], v[168:169]
    v_pk_mul_f32 v[198:199], v[66:67], v[66:67]
    v_pk_mul_f32 v[206:207], v[98:99], v[98:99]
    v_mov_b32 v241, v128
    v_mov_b32 v243, v160
    v_pk_add_f32 v[72:73], v[72:73], v[138:139]
    v_pk_add_f32 v[104:105], v[104:105], v[170:171]
    v_pk_fma_f32 v[196:197], v[68:69], v[68:69], v[196:197]
    v_pk_add_f32 v[192:193], v[64:65], v[68:69]
    v_pk_fma_f32 v[204:205], v[100:101], v[100:101], v[204:205]
    v_pk_add_f32 v[200:201], v[96:97], v[100:101]
    v_permlane32_swap_b32 v128, v241
    v_permlane32_swap_b32 v160, v243
    v_pk_add_f32 v[74:75], v[74:75], v[140:141]
    v_pk_add_f32 v[106:107], v[106:107], v[172:173]
    v_pk_fma_f32 v[198:199], v[70:71], v[70:71], v[198:199]
    v_pk_add_f32 v[194:195], v[66:67], v[70:71]
    v_pk_fma_f32 v[206:207], v[102:103], v[102:103], v[206:207]
    v_pk_add_f32 v[202:203], v[98:99], v[102:103]
    v_cndmask_b32 v240, v240, v241, s[68:69]
    v_cndmask_b32 v242, v242, v243, s[68:69]
    v_pk_add_f32 v[76:77], v[76:77], v[142:143]
    v_pk_add_f32 v[108:109], v[108:109], v[174:175]
    v_pk_fma_f32 v[196:197], v[72:73], v[72:73], v[196:197]
    v_pk_add_f32 v[192:193], v[192:193], v[72:73]
    v_pk_fma_f32 v[204:205], v[104:105], v[104:105], v[204:205]
    v_pk_add_f32 v[200:201], v[200:201], v[104:105]
    v_pk_add_f32 v[78:79], v[78:79], v[144:145]
    v_pk_add_f32 v[110:111], v[110:111], v[176:177]
    v_pk_fma_f32 v[198:199], v[74:75], v[74:75], v[198:199]
    v_pk_add_f32 v[194:195], v[194:195], v[74:75]
    v_pk_fma_f32 v[206:207], v[106:107], v[106:107], v[206:207]
    v_pk_add_f32 v[202:203], v[202:203], v[106:107]
    v_pk_add_f32 v[80:81], v[80:81], v[146:147]
    v_pk_add_f32 v[112:113], v[112:113], v[178:179]
    v_pk_fma_f32 v[196:197], v[76:77], v[76:77], v[196:197]
    v_pk_add_f32 v[192:193], v[192:193], v[76:77]
    v_pk_fma_f32 v[204:205], v[108:109], v[108:109], v[204:205]
    v_pk_add_f32 v[200:201], v[200:201], v[108:109]
    v_pk_add_f32 v[82:83], v[82:83], v[148:149]
    v_pk_add_f32 v[114:115], v[114:115], v[180:181]
    v_pk_fma_f32 v[198:199], v[78:79], v[78:79], v[198:199]
    v_pk_add_f32 v[194:195], v[194:195], v[78:79]
    v_pk_fma_f32 v[206:207], v[110:111], v[110:111], v[206:207]
    v_pk_add_f32 v[202:203], v[202:203], v[110:111]
    v_pk_add_f32 v[84:85], v[84:85], v[150:151]
    v_pk_add_f32 v[116:117], v[116:117], v[182:183]
    v_pk_fma_f32 v[196:197], v[80:81], v[80:81], v[196:197]
    v_pk_add_f32 v[192:193], v[192:193], v[80:81]
    v_pk_fma_f32 v[204:205], v[112:113], v[112:113], v[204:205]
    v_pk_add_f32 v[200:201], v[200:201], v[112:113]
    v_pk_add_f32 v[86:87], v[86:87], v[152:153]
    v_pk_add_f32 v[118:119], v[118:119], v[184:185]
    v_pk_fma_f32 v[198:199], v[82:83], v[82:83], v[198:199]
    v_pk_add_f32 v[194:195], v[194:195], v[82:83]
    v_pk_fma_f32 v[206:207], v[114:115], v[114:115], v[206:207]
    v_pk_add_f32 v[202:203], v[202:203], v[114:115]
    v_pk_add_f32 v[88:89], v[88:89], v[154:155]
    v_pk_add_f32 v[120:121], v[120:121], v[186:187]
    v_pk_fma_f32 v[196:197], v[84:85], v[84:85], v[196:197]
    v_pk_add_f32 v[192:193], v[192:193], v[84:85]
    v_pk_fma_f32 v[204:205], v[116:117], v[116:117], v[204:205]
    v_pk_add_f32 v[200:201], v[200:201], v[116:117]
    v_pk_add_f32 v[90:91], v[90:91], v[156:157]
    v_cndmask_b32 v91, v91, 0, s[66:67]
    v_pk_add_f32 v[122:123], v[122:123], v[188:189]
    v_cndmask_b32 v123, v123, 0, s[66:67]
    v_pk_fma_f32 v[198:199], v[86:87], v[86:87], v[198:199]
    v_pk_add_f32 v[194:195], v[194:195], v[86:87]
    v_pk_fma_f32 v[206:207], v[118:119], v[118:119], v[206:207]
    v_pk_add_f32 v[202:203], v[202:203], v[118:119]
    v_pk_add_f32 v[92:93], v[92:93], v[158:159]
    v_cndmask_b32 v93, v93, 0, s[66:67]
    v_pk_add_f32 v[124:125], v[124:125], v[190:191]
    v_cndmask_b32 v125, v125, 0, s[66:67]
    v_pk_fma_f32 v[196:197], v[88:89], v[88:89], v[196:197]
    v_pk_add_f32 v[192:193], v[192:193], v[88:89]
    v_pk_fma_f32 v[204:205], v[120:121], v[120:121], v[204:205]
    v_pk_add_f32 v[200:201], v[200:201], v[120:121]
    v_add_f32 v94, v94, v129
    v_add_f32 v95, v95, v240
    v_cndmask_b32 v95, v95, 0, s[64:65]
    v_add_f32 v126, v126, v161
    v_add_f32 v127, v127, v242
    v_cndmask_b32 v127, v127, 0, s[64:65]
    v_pk_fma_f32 v[198:199], v[90:91], v[90:91], v[198:199]
    v_pk_add_f32 v[194:195], v[194:195], v[90:91]
    v_pk_fma_f32 v[206:207], v[122:123], v[122:123], v[206:207]
    v_pk_add_f32 v[202:203], v[202:203], v[122:123]
    v_pk_fma_f32 v[196:197], v[92:93], v[92:93], v[196:197]
    v_pk_add_f32 v[192:193], v[192:193], v[92:93]
    v_pk_fma_f32 v[204:205], v[124:125], v[124:125], v[204:205]
    v_pk_add_f32 v[200:201], v[200:201], v[124:125]
    v_pk_fma_f32 v[198:199], v[94:95], v[94:95], v[198:199]
    v_pk_add_f32 v[194:195], v[194:195], v[94:95]
    v_pk_fma_f32 v[206:207], v[126:127], v[126:127], v[206:207]
    v_pk_add_f32 v[202:203], v[202:203], v[126:127]
    v_pk_add_f32 v[192:193], v[192:193], v[194:195]
    v_pk_add_f32 v[196:197], v[196:197], v[198:199]
    v_pk_add_f32 v[200:201], v[200:201], v[202:203]
    v_pk_add_f32 v[204:205], v[204:205], v[206:207]
    v_add_f32 v192, v192, v193
    v_add_f32 v196, v196, v197
    v_add_f32 v200, v200, v201
    v_add_f32 v204, v204, v205
    s_nop 1
    v_permlane16_swap_b32 v192, v200
    v_permlane16_swap_b32 v196, v204
    s_nop 1
    v_add_f32 v192, v192, v200
    v_add_f32 v196, v196, v204
    s_nop 1
    v_permlane32_swap_b32 v192, v196
    s_nop 1
    v_add_f32 v192, v192, v196
    v_cmp_eq_u32 vcc, -1, v192
    v_mov_b32 v193, 0x7fc00000
    s_nop 0
    v_cndmask_b32 v192, v192, v193, vcc
    buffer_store_dword v192, v46, s[32:35], 0 offen sc1
    s_barrier
    ds_write2st64_b32 v49, v64, v65 offset0:0 offset1:32
    ds_write2st64_b32 v49, v66, v67 offset0:2 offset1:34
    ds_write2st64_b32 v49, v68, v69 offset0:4 offset1:36
    ds_write2st64_b32 v49, v70, v71 offset0:6 offset1:38
    ds_write2st64_b32 v49, v72, v73 offset0:8 offset1:40
    ds_write2st64_b32 v49, v74, v75 offset0:10 offset1:42
    ds_write2st64_b32 v49, v76, v77 offset0:12 offset1:44
    ds_write2st64_b32 v49, v78, v79 offset0:14 offset1:46
    ds_write2st64_b32 v49, v80, v81 offset0:16 offset1:48
    ds_write2st64_b32 v49, v82, v83 offset0:18 offset1:50
    ds_write2st64_b32 v49, v84, v85 offset0:20 offset1:52
    ds_write2st64_b32 v49, v86, v87 offset0:22 offset1:54
    ds_write2st64_b32 v49, v88, v89 offset0:24 offset1:56
    ds_write2st64_b32 v49, v90, v91 offset0:26 offset1:58
    ds_write2st64_b32 v49, v92, v93 offset0:28 offset1:60
    ds_write2st64_b32 v49, v94, v95 offset0:30 offset1:62
    ds_write2st64_b32 v50, v96, v97 offset0:0 offset1:32
    ds_write2st64_b32 v50, v98, v99 offset0:2 offset1:34
    ds_write2st64_b32 v50, v100, v101 offset0:4 offset1:36
    ds_write2st64_b32 v50, v102, v103 offset0:6 offset1:38
    ds_write2st64_b32 v50, v104, v105 offset0:8 offset1:40
    ds_write2st64_b32 v50, v106, v107 offset0:10 offset1:42
    ds_write2st64_b32 v50, v108, v109 offset0:12 offset1:44
    ds_write2st64_b32 v50, v110, v111 offset0:14 offset1:46
    ds_write2st64_b32 v50, v112, v113 offset0:16 offset1:48
    ds_write2st64_b32 v50, v114, v115 offset0:18 offset1:50
    ds_write2st64_b32 v50, v116, v117 offset0:20 offset1:52
    ds_write2st64_b32 v50, v118, v119 offset0:22 offset1:54
    ds_write2st64_b32 v50, v120, v121 offset0:24 offset1:56
    ds_write2st64_b32 v50, v122, v123 offset0:26 offset1:58
    ds_write2st64_b32 v50, v124, v125 offset0:28 offset1:60
    ds_write2st64_b32 v50, v126, v127 offset0:30 offset1:62
    v_and_b32 v3, 15, v0
    v_lshrrev_b32 v4, 4, v0
    v_lshlrev_b32 v5, 1, v3
    v_lshrrev_b32 v6, 3, v3
    v_xor_b32 v5, v5, v6
    v_lshlrev_b32 v5, 4, v5
    v_lshl_add_u32 v5, v4, 9, v5
    v_xor_b32 v6, 16, v5
    s_lshl_b32 s54, s49, 8
    v_lshl_add_u32 v8, v4, 9, s54
    v_lshl_add_u32 v8, v3, 4, v8
    v_add_u32 v4, 96, v4
    v_cmp_gt_u32 vcc, s79, v4
    v_mov_b32 v9, 0x7ff00000
    v_lshlrev_b32 v10, 5, v3
    v_cndmask_b32 v9, v9, v8, vcc
    v_add_u32 v10, 65536, v10
    s_waitcnt lgkmcnt(0)
    buffer_load_dwordx4 v[128:131], v54, s[32:35], s71 offen offset:0 sc1
    buffer_load_dwordx4 v[132:135], v54, s[32:35], s71 offen offset:1024 sc1
    buffer_load_dwordx4 v[136:139], v54, s[32:35], s71 offen offset:2048 sc1
    buffer_load_dwordx4 v[140:143], v54, s[32:35], s71 offen offset:3072 sc1
    buffer_load_dwordx4 v[144:147], v54, s[32:35], s72 offen offset:0 sc1
    buffer_load_dwordx4 v[148:151], v54, s[32:35], s72 offen offset:1024 sc1
    buffer_load_dwordx4 v[152:155], v54, s[32:35], s72 offen offset:2048 sc1
    buffer_load_dwordx4 v[156:159], v54, s[32:35], s72 offen offset:3072 sc1
    buffer_load_dwordx4 v[160:163], v54, s[32:35], s73 offen offset:0 sc1
    buffer_load_dwordx4 v[164:167], v54, s[32:35], s73 offen offset:1024 sc1
    buffer_load_dwordx4 v[168:171], v54, s[32:35], s73 offen offset:2048 sc1
    buffer_load_dwordx4 v[172:175], v54, s[32:35], s73 offen offset:3072 sc1
    buffer_load_dwordx4 v[176:179], v54, s[32:35], s74 offen offset:0 sc1
    buffer_load_dwordx4 v[180:183], v54, s[32:35], s74 offen offset:1024 sc1
    buffer_load_dwordx4 v[184:187], v54, s[32:35], s74 offen offset:2048 sc1
    buffer_load_dwordx4 v[188:191], v55, s[32:35], s74 offen offset:3072 sc1
    s_barrier
    ds_read_b128 v[64:67], v5 offset:0
    ds_read_b128 v[68:71], v6 offset:0
    ds_read_b128 v[72:75], v5 offset:16384
    ds_read_b128 v[76:79], v6 offset:16384
    ds_read_b128 v[80:83], v5 offset:32768
    ds_read_b128 v[84:87], v6 offset:32768
    ds_read_b128 v[88:91], v5 offset:49152
    ds_read_b128 v[92:95], v6 offset:49152
    s_mov_b32 s87, 0
    s_waitcnt vmcnt(0)
    v_max3_u32 v240, v128, v129, v130
    v_max_u32 v240, v240, v131
    v_cmp_eq_u32 s[4:5], -1, v240
    v_max3_u32 v241, v132, v133, v134
    v_max_u32 v241, v241, v135
    v_cmp_eq_u32 s[6:7], -1, v241
    v_max3_u32 v242, v136, v137, v138
    v_max_u32 v242, v242, v139
    v_cmp_eq_u32 s[8:9], -1, v242
    v_max3_u32 v243, v140, v141, v142
    v_max_u32 v243, v243, v143
    v_cmp_eq_u32 s[10:11], -1, v243
    v_max3_u32 v240, v144, v145, v146
    v_max_u32 v240, v240, v147
    v_cmp_eq_u32 s[12:13], -1, v240
    v_max3_u32 v241, v148, v149, v150
    v_max_u32 v241, v241, v151
    v_cmp_eq_u32 s[14:15], -1, v241
    v_max3_u32 v242, v152, v153, v154
    v_max_u32 v242, v242, v155
    v_cmp_eq_u32 s[16:17], -1, v242
    v_max3_u32 v243, v156, v157, v158
    v_max_u32 v243, v243, v159
    v_cmp_eq_u32 s[18:19], -1, v243
    v_max3_u32 v240, v160, v161, v162
    v_max_u32 v240, v240, v163
    v_cmp_eq_u32 s[20:21], -1, v240
    v_max3_u32 v241, v164, v165, v166
    v_max_u32 v241, v241, v167
    v_cmp_eq_u32 s[22:23], -1, v241
    v_max3_u32 v242, v168, v169, v170
    v_max_u32 v242, v242, v171
    v_cmp_eq_u32 s[24:25], -1, v242
    v_max3_u32 v243, v172, v173, v174
    v_max_u32 v243, v243, v175
    v_cmp_eq_u32 s[26:27], -1, v243
    v_max3_u32 v240, v176, v177, v178
    v_max_u32 v240, v240, v179
    v_cmp_eq_u32 s[40:41], -1, v240
    v_max3_u32 v241, v180, v181, v182
    v_max_u32 v241, v241, v183
    v_cmp_eq_u32 s[42:43], -1, v241
    v_max3_u32 v242, v184, v185, v186
    v_max_u32 v242, v242, v187
    v_cmp_eq_u32 s[44:45], -1, v242
    v_max3_u32 v243, v188, v189, v190
    v_max_u32 v243, v243, v191
    v_cmp_eq_u32 s[46:47], -1, v243
L_poll:
    s_or_b64 s[92:93], s[4:5], s[6:7]
    s_or_b64 s[92:93], s[92:93], s[8:9]
    s_or_b64 s[92:93], s[92:93], s[10:11]
    s_or_b64 s[92:93], s[92:93], s[12:13]
    s_or_b64 s[92:93], s[92:93], s[14:15]
    s_or_b64 s[92:93], s[92:93], s[16:17]
    s_or_b64 s[92:93], s[92:93], s[18:19]
    s_or_b64 s[92:93], s[92:93], s[20:21]
    s_or_b64 s[92:93], s[92:93], s[22:23]
    s_or_b64 s[92:93], s[92:93], s[24:25]
    s_or_b64 s[92:93], s[92:93], s[26:27]
    s_or_b64 s[92:93], s[92:93], s[40:41]
    s_or_b64 s[92:93], s[92:93], s[42:43]
    s_or_b64 s[92:93], s[92:93], s[44:45]
    s_or_b64 s[92:93], s[92:93], s[46:47]
    s_cbranch_scc0 L_pdone
    s_add_u32 s87, s87, 1
    s_cmp_gt_u32 s87, 200000
    s_cbranch_scc1 L_pdone
    s_mov_b64 exec, s[4:5]
    s_cbranch_execz L_pl_18
    buffer_load_dwordx4 v[128:131], v54, s[32:35], s71 offen offset:0 sc1
L_pl_18:
    s_mov_b64 exec, s[6:7]
    s_cbranch_execz L_pl_19
    buffer_load_dwordx4 v[132:135], v54, s[32:35], s71 offen offset:1024 sc1
L_pl_19:
    s_mov_b64 exec, s[8:9]
    s_cbranch_execz L_pl_20
    buffer_load_dwordx4 v[136:139], v54, s[32:35], s71 offen offset:2048 sc1
L_pl_20:
    s_mov_b64 exec, s[10:11]
    s_cbranch_execz L_pl_21
    buffer_load_dwordx4 v[140:143], v54, s[32:35], s71 offen offset:3072 sc1
L_pl_21:
    s_mov_b64 exec, s[12:13]
    s_cbranch_execz L_pl_22
    buffer_load_dwordx4 v[144:147], v54, s[32:35], s72 offen offset:0 sc1
L_pl_22:
    s_mov_b64 exec, s[14:15]
    s_cbranch_execz L_pl_23
    buffer_load_dwordx4 v[148:151], v54, s[32:35], s72 offen offset:1024 sc1
L_pl_23:
    s_mov_b64 exec, s[16:17]
    s_cbranch_execz L_pl_24
    buffer_load_dwordx4 v[152:155], v54, s[32:35], s72 offen offset:2048 sc1
L_pl_24:
    s_mov_b64 exec, s[18:19]
    s_cbranch_execz L_pl_25
    buffer_load_dwordx4 v[156:159], v54, s[32:35], s72 offen offset:3072 sc1
L_pl_25:
    s_mov_b64 exec, s[20:21]
    s_cbranch_execz L_pl_26
    buffer_load_dwordx4 v[160:163], v54, s[32:35], s73 offen offset:0 sc1
L_pl_26:
    s_mov_b64 exec, s[22:23]
    s_cbranch_execz L_pl_27
    buffer_load_dwordx4 v[164:167], v54, s[32:35], s73 offen offset:1024 sc1
L_pl_27:
    s_mov_b64 exec, s[24:25]
    s_cbranch_execz L_pl_28
    buffer_load_dwordx4 v[168:171], v54, s[32:35], s73 offen offset:2048 sc1
L_pl_28:
    s_mov_b64 exec, s[26:27]
    s_cbranch_execz L_pl_29
    buffer_load_dwordx4 v[172:175], v54, s[32:35], s73 offen offset:3072 sc1
L_pl_29:
    s_mov_b64 exec, s[40:41]
    s_cbranch_execz L_pl_30
    buffer_load_dwordx4 v[176:179], v54, s[32:35], s74 offen offset:0 sc1
L_pl_30:
    s_mov_b64 exec, s[42:43]
    s_cbranch_execz L_pl_31
    buffer_load_dwordx4 v[180:183], v54, s[32:35], s74 offen offset:1024 sc1
L_pl_31:
    s_mov_b64 exec, s[44:45]
    s_cbranch_execz L_pl_32
    buffer_load_dwordx4 v[184:187], v54, s[32:35], s74 offen offset:2048 sc1
L_pl_32:
    s_mov_b64 exec, s[46:47]
    s_cbranch_execz L_pl_33
    buffer_load_dwordx4 v[188:191], v55, s[32:35], s74 offen offset:3072 sc1
L_pl_33:
    s_waitcnt vmcnt(0)
    s_mov_b64 exec, s[4:5]
    s_cbranch_execz L_pc_34
    v_max3_u32 v240, v128, v129, v130
    v_max_u32 v240, v240, v131
    v_cmp_eq_u32 s[4:5], -1, v240
L_pc_34:
    s_mov_b64 exec, s[6:7]
    s_cbranch_execz L_pc_35
    v_max3_u32 v240, v132, v133, v134
    v_max_u32 v240, v240, v135
    v_cmp_eq_u32 s[6:7], -1, v240
L_pc_35:
    s_mov_b64 exec, s[8:9]
    s_cbranch_execz L_pc_36
    v_max3_u32 v240, v136, v137, v138
    v_max_u32 v240, v240, v139
    v_cmp_eq_u32 s[8:9], -1, v240
L_pc_36:
    s_mov_b64 exec, s[10:11]
    s_cbranch_execz L_pc_37
    v_max3_u32 v240, v140, v141, v142
    v_max_u32 v240, v240, v143
    v_cmp_eq_u32 s[10:11], -1, v240
L_pc_37:
    s_mov_b64 exec, s[12:13]
    s_cbranch_execz L_pc_38
    v_max3_u32 v240, v144, v145, v146
    v_max_u32 v240, v240, v147
    v_cmp_eq_u32 s[12:13], -1, v240
L_pc_38:
    s_mov_b64 exec, s[14:15]
    s_cbranch_execz L_pc_39
    v_max3_u32 v240, v148, v149, v150
    v_max_u32 v240, v240, v151
    v_cmp_eq_u32 s[14:15], -1, v240
L_pc_39:
    s_mov_b64 exec, s[16:17]
    s_cbranch_execz L_pc_40
    v_max3_u32 v240, v152, v153, v154
    v_max_u32 v240, v240, v155
    v_cmp_eq_u32 s[16:17], -1, v240
L_pc_40:
    s_mov_b64 exec, s[18:19]
    s_cbranch_execz L_pc_41
    v_max3_u32 v240, v156, v157, v158
    v_max_u32 v240, v240, v159
    v_cmp_eq_u32 s[18:19], -1, v240
L_pc_41:
    s_mov_b64 exec, s[20:21]
    s_cbranch_execz L_pc_42
    v_max3_u32 v240, v160, v161, v162
    v_max_u32 v240, v240, v163
    v_cmp_eq_u32 s[20:21], -1, v240
L_pc_42:
    s_mov_b64 exec, s[22:23]
    s_cbranch_execz L_pc_43
    v_max3_u32 v240, v164, v165, v166
    v_max_u32 v240, v240, v167
    v_cmp_eq_u32 s[22:23], -1, v240
L_pc_43:
    s_mov_b64 exec, s[24:25]
    s_cbranch_execz L_pc_44
    v_max3_u32 v240, v168, v169, v170
    v_max_u32 v240, v240, v171
    v_cmp_eq_u32 s[24:25], -1, v240
L_pc_44:
    s_mov_b64 exec, s[26:27]
    s_cbranch_execz L_pc_45
    v_max3_u32 v240, v172, v173, v174
    v_max_u32 v240, v240, v175
    v_cmp_eq_u32 s[26:27], -1, v240
L_pc_45:
    s_mov_b64 exec, s[40:41]
    s_cbranch_execz L_pc_46
    v_max3_u32 v240, v176, v177, v178
    v_max_u32 v240, v240, v179
    v_cmp_eq_u32 s[40:41], -1, v240
L_pc_46:
    s_mov_b64 exec, s[42:43]
    s_cbranch_execz L_pc_47
    v_max3_u32 v240, v180, v181, v182
    v_max_u32 v240, v240, v183
    v_cmp_eq_u32 s[42:43], -1, v240
L_pc_47:
    s_mov_b64 exec, s[44:45]
    s_cbranch_execz L_pc_48
    v_max3_u32 v240, v184, v185, v186
    v_max_u32 v240, v240, v187
    v_cmp_eq_u32 s[44:45], -1, v240
L_pc_48:
    s_mov_b64 exec, s[46:47]
    s_cbranch_execz L_pc_49
    v_max3_u32 v240, v188, v189, v190
    v_max_u32 v240, v240, v191
    v_cmp_eq_u32 s[46:47], -1, v240
L_pc_49:
    s_mov_b64 exec, -1
    s_branch L_poll
L_pdone:
    s_mov_b64 exec, -1
    v_pk_add_f32 v[128:129], v[128:129], v[132:133]
    v_pk_add_f32 v[130:131], v[130:131], v[134:135]
    v_pk_add_f32 v[136:137], v[136:137], v[140:141]
    v_pk_add_f32 v[138:139], v[138:139], v[142:143]
    v_pk_add_f32 v[144:145], v[144:145], v[148:149]
    v_pk_add_f32 v[146:147], v[146:147], v[150:151]
    v_pk_add_f32 v[152:153], v[152:153], v[156:157]
    v_pk_add_f32 v[154:155], v[154:155], v[158:159]
    v_pk_add_f32 v[160:161], v[160:161], v[164:165]
    v_pk_add_f32 v[162:163], v[162:163], v[166:167]
    v_pk_add_f32 v[168:169], v[168:169], v[172:173]
    v_pk_add_f32 v[170:171], v[170:171], v[174:175]
    v_pk_add_f32 v[176:177], v[176:177], v[180:181]
    v_pk_add_f32 v[178:179], v[178:179], v[182:183]
    v_pk_add_f32 v[184:185], v[184:185], v[188:189]
    v_pk_add_f32 v[186:187], v[186:187], v[190:191]
    v_pk_add_f32 v[128:129], v[128:129], v[136:137]
    v_pk_add_f32 v[130:131], v[130:131], v[138:139]
    v_pk_add_f32 v[144:145], v[144:145], v[152:153]
    v_pk_add_f32 v[146:147], v[146:147], v[154:155]
    v_pk_add_f32 v[160:161], v[160:161], v[168:169]
    v_pk_add_f32 v[162:163], v[162:163], v[170:171]
    v_pk_add_f32 v[176:177], v[176:177], v[184:185]
    v_pk_add_f32 v[178:179], v[178:179], v[186:187]
    v_pk_add_f32 v[128:129], v[128:129], v[144:145]
    v_pk_add_f32 v[130:131], v[130:131], v[146:147]
    v_pk_add_f32 v[160:161], v[160:161], v[176:177]
    v_pk_add_f32 v[162:163], v[162:163], v[178:179]
    v_pk_add_f32 v[128:129], v[128:129], v[160:161]
    v_pk_add_f32 v[130:131], v[130:131], v[162:163]
    s_nop 1
    v_permlane16_swap_b32 v128, v129
    v_permlane16_swap_b32 v130, v131
    s_nop 1
    v_add_f32 v128, v128, v129
    v_add_f32 v130, v130, v131
    s_nop 1
    v_permlane32_swap_b32 v128, v130
    s_nop 1
    v_add_f32 v128, v128, v130
    s_nop 1
    v_mov_b32_dpp v129, v128 row_ror:8 row_mask:0xf bank_mask:0xf
    v_mul_f32 v128, 0x390316a0, v128
    v_mul_f32 v129, 0x390316a0, v129
    v_fma_f32 v129, -v128, v128, v129
    v_max_f32 v129, 0, v129
    v_add_f32 v129, 0x3727c5ac, v129
    v_rsq_f32 v129, v129
    v_lshlrev_b32 v47, 16, v47
    v_lshlrev_b32 v48, 16, v48
    v_mul_f32 v47, 0xbeeff558, v47
    v_mul_f32 v48, 0xbeeff558, v48
    v_mul_f32 v129, v129, v47
    v_fma_f32 v128, -v128, v129, v48
    s_mov_b32 s54, 0x00ff00ff
    s_mov_b32 exec_lo, s54
    s_mov_b32 exec_hi, s54
    ds_write2_b32 v53, v129, v128 offset0:0 offset1:128
    s_mov_b64 exec, -1
    s_waitcnt lgkmcnt(0)
    s_barrier
L_epi:
    ds_read_b128 v[16:19], v10
    ds_read_b128 v[20:23], v10 offset:16
    ds_read_b128 v[24:27], v10 offset:512
    ds_read_b128 v[28:31], v10 offset:528
    s_mov_b32 s80, 0x409d30fc
    s_mov_b32 s81, 0x409d30fc
    s_mov_b32 s82, 0xbeeff558
    s_mov_b32 s83, 0xbeeff558
    s_waitcnt lgkmcnt(0)
    v_pk_fma_f32 v[64:65], v[64:65], v[16:17], v[24:25]
    v_pk_fma_f32 v[66:67], v[66:67], v[18:19], v[26:27]
    v_pk_fma_f32 v[68:69], v[68:69], v[20:21], v[28:29]
    v_pk_fma_f32 v[70:71], v[70:71], v[22:23], v[30:31]
    v_pk_fma_f32 v[32:33], v[64:65], v[64:65], s[80:81]
    v_pk_fma_f32 v[34:35], v[66:67], v[66:67], s[80:81]
    v_pk_fma_f32 v[36:37], v[68:69], v[68:69], s[80:81]
    v_pk_fma_f32 v[38:39], v[70:71], v[70:71], s[80:81]
    v_pk_mul_f32 v[32:33], v[32:33], v[64:65]
    v_pk_mul_f32 v[34:35], v[34:35], v[66:67]
    v_pk_mul_f32 v[36:37], v[36:37], v[68:69]
    v_pk_mul_f32 v[38:39], v[38:39], v[70:71]
    v_exp_f32 v32, v32
    v_exp_f32 v33, v33
    v_exp_f32 v34, v34
    v_exp_f32 v35, v35
    v_exp_f32 v36, v36
    v_exp_f32 v37, v37
    v_exp_f32 v38, v38
    v_exp_f32 v39, v39
    v_pk_fma_f32 v[32:33], v[32:33], s[82:83], s[82:83]
    v_pk_fma_f32 v[34:35], v[34:35], s[82:83], s[82:83]
    v_pk_fma_f32 v[36:37], v[36:37], s[82:83], s[82:83]
    v_pk_fma_f32 v[38:39], v[38:39], s[82:83], s[82:83]
    v_rcp_f32 v32, v32
    v_rcp_f32 v33, v33
    v_rcp_f32 v34, v34
    v_rcp_f32 v35, v35
    v_rcp_f32 v36, v36
    v_rcp_f32 v37, v37
    v_rcp_f32 v38, v38
    v_rcp_f32 v39, v39
    v_pk_mul_f32 v[32:33], v[32:33], v[64:65]
    v_pk_mul_f32 v[34:35], v[34:35], v[66:67]
    v_pk_mul_f32 v[36:37], v[36:37], v[68:69]
    v_pk_mul_f32 v[38:39], v[38:39], v[70:71]
    v_cvt_pk_bf16_f32 v48, v32, v33
    v_cvt_pk_bf16_f32 v49, v34, v35
    v_cvt_pk_bf16_f32 v50, v36, v37
    v_cvt_pk_bf16_f32 v51, v38, v39
    buffer_store_dwordx4 v[48:51], v8, s[28:31], s75 offen sc0 sc1
    v_pk_fma_f32 v[72:73], v[72:73], v[16:17], v[24:25]
    v_pk_fma_f32 v[74:75], v[74:75], v[18:19], v[26:27]
    v_pk_fma_f32 v[76:77], v[76:77], v[20:21], v[28:29]
    v_pk_fma_f32 v[78:79], v[78:79], v[22:23], v[30:31]
    v_pk_fma_f32 v[40:41], v[72:73], v[72:73], s[80:81]
    v_pk_fma_f32 v[42:43], v[74:75], v[74:75], s[80:81]
    v_pk_fma_f32 v[44:45], v[76:77], v[76:77], s[80:81]
    v_pk_fma_f32 v[46:47], v[78:79], v[78:79], s[80:81]
    v_pk_mul_f32 v[40:41], v[40:41], v[72:73]
    v_pk_mul_f32 v[42:43], v[42:43], v[74:75]
    v_pk_mul_f32 v[44:45], v[44:45], v[76:77]
    v_pk_mul_f32 v[46:47], v[46:47], v[78:79]
    v_exp_f32 v40, v40
    v_exp_f32 v41, v41
    v_exp_f32 v42, v42
    v_exp_f32 v43, v43
    v_exp_f32 v44, v44
    v_exp_f32 v45, v45
    v_exp_f32 v46, v46
    v_exp_f32 v47, v47
    v_pk_fma_f32 v[40:41], v[40:41], s[82:83], s[82:83]
    v_pk_fma_f32 v[42:43], v[42:43], s[82:83], s[82:83]
    v_pk_fma_f32 v[44:45], v[44:45], s[82:83], s[82:83]
    v_pk_fma_f32 v[46:47], v[46:47], s[82:83], s[82:83]
    v_rcp_f32 v40, v40
    v_rcp_f32 v41, v41
    v_rcp_f32 v42, v42
    v_rcp_f32 v43, v43
    v_rcp_f32 v44, v44
    v_rcp_f32 v45, v45
    v_rcp_f32 v46, v46
    v_rcp_f32 v47, v47
    v_pk_mul_f32 v[40:41], v[40:41], v[72:73]
    v_pk_mul_f32 v[42:43], v[42:43], v[74:75]
    v_pk_mul_f32 v[44:45], v[44:45], v[76:77]
    v_pk_mul_f32 v[46:47], v[46:47], v[78:79]
    v_cvt_pk_bf16_f32 v52, v40, v41
    v_cvt_pk_bf16_f32 v53, v42, v43
    v_cvt_pk_bf16_f32 v54, v44, v45
    v_cvt_pk_bf16_f32 v55, v46, v47
    buffer_store_dwordx4 v[52:55], v8, s[28:31], s76 offen sc0 sc1
    v_pk_fma_f32 v[80:81], v[80:81], v[16:17], v[24:25]
    v_pk_fma_f32 v[82:83], v[82:83], v[18:19], v[26:27]
    v_pk_fma_f32 v[84:85], v[84:85], v[20:21], v[28:29]
    v_pk_fma_f32 v[86:87], v[86:87], v[22:23], v[30:31]
    v_pk_fma_f32 v[32:33], v[80:81], v[80:81], s[80:81]
    v_pk_fma_f32 v[34:35], v[82:83], v[82:83], s[80:81]
    v_pk_fma_f32 v[36:37], v[84:85], v[84:85], s[80:81]
    v_pk_fma_f32 v[38:39], v[86:87], v[86:87], s[80:81]
    v_pk_mul_f32 v[32:33], v[32:33], v[80:81]
    v_pk_mul_f32 v[34:35], v[34:35], v[82:83]
    v_pk_mul_f32 v[36:37], v[36:37], v[84:85]
    v_pk_mul_f32 v[38:39], v[38:39], v[86:87]
    v_exp_f32 v32, v32
    v_exp_f32 v33, v33
    v_exp_f32 v34, v34
    v_exp_f32 v35, v35
    v_exp_f32 v36, v36
    v_exp_f32 v37, v37
    v_exp_f32 v38, v38
    v_exp_f32 v39, v39
    v_pk_fma_f32 v[32:33], v[32:33], s[82:83], s[82:83]
    v_pk_fma_f32 v[34:35], v[34:35], s[82:83], s[82:83]
    v_pk_fma_f32 v[36:37], v[36:37], s[82:83], s[82:83]
    v_pk_fma_f32 v[38:39], v[38:39], s[82:83], s[82:83]
    v_rcp_f32 v32, v32
    v_rcp_f32 v33, v33
    v_rcp_f32 v34, v34
    v_rcp_f32 v35, v35
    v_rcp_f32 v36, v36
    v_rcp_f32 v37, v37
    v_rcp_f32 v38, v38
    v_rcp_f32 v39, v39
    v_pk_mul_f32 v[32:33], v[32:33], v[80:81]
    v_pk_mul_f32 v[34:35], v[34:35], v[82:83]
    v_pk_mul_f32 v[36:37], v[36:37], v[84:85]
    v_pk_mul_f32 v[38:39], v[38:39], v[86:87]
    v_cvt_pk_bf16_f32 v48, v32, v33
    v_cvt_pk_bf16_f32 v49, v34, v35
    v_cvt_pk_bf16_f32 v50, v36, v37
    v_cvt_pk_bf16_f32 v51, v38, v39
    buffer_store_dwordx4 v[48:51], v8, s[28:31], s77 offen sc0 sc1
    v_pk_fma_f32 v[88:89], v[88:89], v[16:17], v[24:25]
    v_pk_fma_f32 v[90:91], v[90:91], v[18:19], v[26:27]
    v_pk_fma_f32 v[92:93], v[92:93], v[20:21], v[28:29]
    v_pk_fma_f32 v[94:95], v[94:95], v[22:23], v[30:31]
    v_pk_fma_f32 v[40:41], v[88:89], v[88:89], s[80:81]
    v_pk_fma_f32 v[42:43], v[90:91], v[90:91], s[80:81]
    v_pk_fma_f32 v[44:45], v[92:93], v[92:93], s[80:81]
    v_pk_fma_f32 v[46:47], v[94:95], v[94:95], s[80:81]
    v_pk_mul_f32 v[40:41], v[40:41], v[88:89]
    v_pk_mul_f32 v[42:43], v[42:43], v[90:91]
    v_pk_mul_f32 v[44:45], v[44:45], v[92:93]
    v_pk_mul_f32 v[46:47], v[46:47], v[94:95]
    v_exp_f32 v40, v40
    v_exp_f32 v41, v41
    v_exp_f32 v42, v42
    v_exp_f32 v43, v43
    v_exp_f32 v44, v44
    v_exp_f32 v45, v45
    v_exp_f32 v46, v46
    v_exp_f32 v47, v47
    v_pk_fma_f32 v[40:41], v[40:41], s[82:83], s[82:83]
    v_pk_fma_f32 v[42:43], v[42:43], s[82:83], s[82:83]
    v_pk_fma_f32 v[44:45], v[44:45], s[82:83], s[82:83]
    v_pk_fma_f32 v[46:47], v[46:47], s[82:83], s[82:83]
    v_rcp_f32 v40, v40
    v_rcp_f32 v41, v41
    v_rcp_f32 v42, v42
    v_rcp_f32 v43, v43
    v_rcp_f32 v44, v44
    v_rcp_f32 v45, v45
    v_rcp_f32 v46, v46
    v_rcp_f32 v47, v47
    v_pk_mul_f32 v[40:41], v[40:41], v[88:89]
    v_pk_mul_f32 v[42:43], v[42:43], v[90:91]
    v_pk_mul_f32 v[44:45], v[44:45], v[92:93]
    v_pk_mul_f32 v[46:47], v[46:47], v[94:95]
    v_cvt_pk_bf16_f32 v52, v40, v41
    v_cvt_pk_bf16_f32 v53, v42, v43
    v_cvt_pk_bf16_f32 v54, v44, v45
    v_cvt_pk_bf16_f32 v55, v46, v47
    buffer_store_dwordx4 v[52:55], v9, s[28:31], s78 offen sc0 sc1
L_end:
    s_endpgm
L_codeend:
.section .rodata,"a"
.p2align 6
.amdhsa_kernel standalone__self_sup_conv_stem_wavlm__speech_kernel
  .amdhsa_next_free_vgpr 256
  .amdhsa_next_free_sgpr 102
  .amdhsa_accum_offset 256
  .amdhsa_group_segment_fixed_size 0
  .amdhsa_kernarg_size 56
  .amdhsa_user_sgpr_count 2
  .amdhsa_user_sgpr_kernarg_segment_ptr 1
  .amdhsa_system_sgpr_workgroup_id_x 1
.end_amdhsa_kernel
```
